```python
import torch

def _softmax(x, axis=-1):
    return torch.softmax(x, dim=axis)
def _gelu(x):
    return torch.nn.functional.gelu(x, approximate="tanh")
def _silu(x):
    return torch.nn.functional.silu(x)
def _sigmoid(x):
    return torch.sigmoid(x)
def _layernorm(x, axis=-1, eps=1e-5):
    m = x.mean(dim=axis, keepdim=True)
    v = x.var(dim=axis, keepdim=True, unbiased=False)
    return (x - m) / torch.sqrt(v + eps)
def _scatter_add(tgt, idx, src, axis=0):
    return tgt.clone().index_add_(axis, idx, src)
def _segment_sum(src, seg, n):
    out = torch.zeros((n,) + src.shape[1:], dtype=src.dtype)
    return out.index_add_(0, seg, src)
def _pad(x, pw):
    flat = tuple(v for pair in reversed(pw) for v in pair)
    return torch.nn.functional.pad(x, flat)

kernel_name = 'parallel_sum__gqa_block_cached__dense_activation_squared_relu__decode'

def setup_inputs():

    _w = (lambda a: (lambda t: t.to(torch.bfloat16) if t.is_floating_point() else t)(torch.as_tensor(a)))
    def _A_setup():
        B, Sq, D = 2, 1, 576
        Hq, Hkv, Sk, Dh = 32, 16, 32768, 128
        assert Hq % Hkv == 0, (Hq, Hkv)
        return {
            "x": _w((lambda *s: torch.randn(*s, dtype=torch.bfloat16) * 0.05)(B, Sq, D)),
            "k_cache": _w((lambda *s: torch.randn(*s, dtype=torch.bfloat16) * 3.2)(B, Hkv, Sk, Dh)),
            "v_cache": _w((lambda *s: torch.randn(*s, dtype=torch.bfloat16) * 1.6)(B, Hkv, Sk, Dh)),
            "wq": _w((lambda *s: torch.randn(*s, dtype=torch.bfloat16) * 3.2)(D, Hq * Dh) * (D ** -0.5)),
            "wo": _w((lambda *s: torch.randn(*s, dtype=torch.bfloat16) * 1.6)(Hq * Dh, D) * ((Hq * Dh) ** -0.5)),
        }
    _A_in = _A_setup()

    def _B_setup():
        B, S, D, F = 2, 1, 576, 4608
        return {
            "x": _w((lambda *s: torch.randn(*s, dtype=torch.bfloat16) * 0.05)(B, S, D)),
            "w1": _w((lambda *s: torch.randn(*s, dtype=torch.bfloat16) * 0.05)(D, F)),
            "b1": _w((lambda *s: torch.randn(*s, dtype=torch.bfloat16) * 0.05)(F)),
            "w2": _w((lambda *s: torch.randn(*s, dtype=torch.bfloat16) * 0.05)(F, D)),
            "b2": _w((lambda *s: torch.randn(*s, dtype=torch.bfloat16) * 0.05)(D)),
        }
    _B_in = _B_setup()

    return {
        "A_x": _A_in["x"],
        "A_k_cache": _A_in["k_cache"],
        "A_v_cache": _A_in["v_cache"],
        "A_wq": _A_in["wq"],
        "A_wo": _A_in["wo"],
        "B_x": _B_in["x"],
        "B_w1": _B_in["w1"],
        "B_b1": _B_in["b1"],
        "B_w2": _B_in["w2"],
        "B_b2": _B_in["b2"],
    }

def reference(A_x, A_k_cache, A_v_cache, A_wq, A_wo, B_x, B_w1, B_b1, B_w2, B_b2):
    def _A_ref(x, k_cache, v_cache, wq, wo):
        B, Sq, D = x.shape
        Hq, Dh = 32, 128
        Hkv = k_cache.shape[1]
        rep = Hq // Hkv
        q = (lambda x, *d: x.permute(*d))((x @ wq).reshape(B, Sq, Hq, Dh), 0, 2, 1, 3)
        k = (lambda x, n, axis: torch.repeat_interleave(x, n, dim=axis))(k_cache, rep, axis=1)
        v = (lambda x, n, axis: torch.repeat_interleave(x, n, dim=axis))(v_cache, rep, axis=1)
        scores = torch.einsum("bhqd,bhkd->bhqk", q, k) * (Dh ** -0.5)
        p = _softmax(scores, axis=-1)
        o = torch.einsum("bhqk,bhkd->bhqd", p, v)
        return (lambda x, *d: x.permute(*d))(o, 0, 2, 1, 3).reshape(B, Sq, Hq * Dh) @ wo

    def _B_ref(x, w1, b1, w2, b2):
        h = torch.einsum("bsd,df->bsf", x, w1) + b1
        zero = torch.zeros_like(h)
        r = torch.where(h > zero, h, zero)
        h = r * r
        out = torch.einsum("bsf,fd->bsd", h, w2) + b2
        return out

    x = A_x
    xn = _layernorm(x, axis=-1)
    return x + _A_ref(xn, A_k_cache, A_v_cache, A_wq, A_wo) + _B_ref(xn, B_w1, B_b1, B_w2, B_b2)
```

```asm
; @launch grid=(256,1,1) block=(512,1,1) lds=156672
.amdgcn_target "amdgcn-amd-amdhsa--gfx950"
.text
.globl parallel_sum__gqa_block_cached__dense_activation_squared_relu__decode_kernel
.p2align 8
.type parallel_sum__gqa_block_cached__dense_activation_squared_relu__decode_kernel,@function
parallel_sum__gqa_block_cached__dense_activation_squared_relu__decode_kernel:
  s_cmp_ge_u32 s2, 256
  s_cbranch_scc1 L_exit
  s_load_dwordx8 s[8:15], s[0:1], 0
  s_load_dwordx2 s[28:29], s[0:1], 96
  s_load_dwordx8 s[20:27], s[0:1], 48
  s_load_dwordx2 s[16:17], s[0:1], 32
  s_load_dwordx2 s[18:19], s[0:1], 80
  s_and_b32 s62, s2, 7
  s_lshr_b32 s63, s2, 3
  s_and_b32 s32, s63, 7
  s_bfe_u32 s64, s63, 0x10003
  s_lshr_b32 s30, s63, 4
  s_lshl_b32 s64, s64, 3
  s_or_b32 s31, s62, s64
  s_lshl_b32 s33, s30, 4
  s_or_b32 s33, s33, s31
  s_lshr_b32 s76, s2, 3
  s_and_b32 s77, s2, 7
  v_and_b32 v1, 63, v0
  v_lshrrev_b32 v15, 6, v0
  v_mul_u32_u24 v5, 24, v1
  v_readfirstlane_b32 s34, v15
  v_lshrrev_b32 v16, 4, v1
  v_and_b32 v17, 15, v1
  v_lshrrev_b32 v18, 2, v17
  v_mul_u32_u24 v4, 18, v16
  v_add_u32 v4, v4, v18
  v_lshlrev_b32 v4, 13, v4
  v_and_b32 v19, 3, v17
  v_lshl_add_u32 v4, v19, 4, v4
  s_mul_i32 s62, s30, 1152
  s_lshl_b32 s65, s30, 8
  s_lshl_b32 s63, s31, 9
  s_lshl_b32 s64, s32, 6
  s_add_u32 s63, s63, s64
  s_sub_u32 s96, 4718592, s63
  s_mul_i32 s64, s34, 589824
  s_waitcnt lgkmcnt(0)
  s_add_u32 s48, s8, s62
  s_addc_u32 s49, s9, 0
  s_and_b32 s49, s49, 0xffff
  s_mov_b32 s50, 1152
  s_mov_b32 s51, 0x20000
  s_cmp_eq_u32 s34, 0
  s_cbranch_scc0 L_nox
  buffer_load_dwordx4 v[24:27], v5, s[48:51], 0 offen nt
  buffer_load_dwordx2 v[28:29], v5, s[48:51], 0 offen offset:16 nt
L_nox:
  s_add_u32 s52, s14, s63
  s_addc_u32 s53, s15, 0
  s_and_b32 s53, s53, 0xffff
  s_mov_b32 s54, s96
  s_mov_b32 s55, 0x20000
  buffer_load_dwordx4 v[64:67], v4, s[52:55], s64 offen nt
  s_add_u32 s64, s64, 32768
  buffer_load_dwordx4 v[68:71], v4, s[52:55], s64 offen nt
  s_add_u32 s64, s64, 32768
  buffer_load_dwordx4 v[72:75], v4, s[52:55], s64 offen nt
  s_add_u32 s64, s64, 32768
  buffer_load_dwordx4 v[76:79], v4, s[52:55], s64 offen nt
  s_add_u32 s64, s64, 32768
  buffer_load_dwordx4 v[80:83], v4, s[52:55], s64 offen nt
  s_load_dword s35, s[28:29], s65
  s_mov_b32 s91, 0x3fb8aa3b
  s_mov_b32 s92, 0x3db504f3
  v_lshlrev_b32 v18, 8, v18
  v_lshl_add_u32 v18, v16, 6, v18
  v_lshl_add_u32 v2, v19, 4, v18
  v_lshlrev_b32 v3, 4, v1
  v_mul_u32_u24 v45, 36, v16
  v_and_b32 v15, 7, v1
  v_lshrrev_b32 v16, 1, v15
  v_cmp_eq_u32 s[66:67], 0, v16
  v_cmp_eq_u32 s[68:69], 1, v16
  v_cmp_eq_u32 s[70:71], 2, v16
  v_cmp_eq_u32 s[72:73], 3, v16
  v_bfe_u32 v16, v1, 3, 1
  v_cmp_eq_u32 s[74:75], 1, v16
  v_and_b32 v6, 1, v1
  v_cmp_eq_u32 vcc, 1, v6
  v_mov_b32 v6, 0x0c0c0100
  v_mov_b32 v7, 0x01000c0c
  v_cndmask_b32 v6, v6, v7, vcc
  v_mov_b32 v7, 0x0c0c0302
  v_mov_b32 v8, 0x03020c0c
  v_cndmask_b32 v7, v7, v8, vcc
  v_mov_b32 v8, 0x0c0c0c0c
  v_cndmask_b32 v94, v8, v6, s[66:67]
  v_cndmask_b32 v98, v8, v7, s[66:67]
  v_cndmask_b32 v95, v8, v6, s[68:69]
  v_cndmask_b32 v99, v8, v7, s[68:69]
  v_cndmask_b32 v96, v8, v6, s[70:71]
  v_cndmask_b32 v100, v8, v7, s[70:71]
  v_cndmask_b32 v97, v8, v6, s[72:73]
  v_cndmask_b32 v101, v8, v7, s[72:73]
  v_cndmask_b32 v102, v94, v98, s[74:75]
  v_cndmask_b32 v103, v95, v99, s[74:75]
  v_cndmask_b32 v104, v96, v100, s[74:75]
  v_cndmask_b32 v105, v97, v101, s[74:75]
  v_bfe_u32 v9, v1, 1, 1
  v_cmp_eq_u32 vcc, 1, v9
  s_nop 1
  v_cndmask_b32 v106, v6, v8, vcc
  v_cndmask_b32 v107, v8, v6, vcc
  v_cndmask_b32 v108, v7, v8, vcc
  v_cndmask_b32 v109, v8, v7, vcc
  s_lshl_b32 s62, s76, 23
  s_add_u32 s36, s10, s62
  s_addc_u32 s37, s11, 0
  s_and_b32 s37, s37, 0xffff
  s_mov_b32 s38, 8388608
  s_mov_b32 s39, 0x20000
  s_add_u32 s40, s12, s62
  s_addc_u32 s41, s13, 0
  s_and_b32 s41, s41, 0xffff
  s_mov_b32 s42, 8388608
  s_mov_b32 s43, 0x20000
  s_mul_i32 s60, s34, 2048
  s_lshl_b32 s62, s77, 20
  s_add_u32 s60, s60, s62
  s_add_u32 s60, s60, 32768
  s_barrier
  s_cmp_eq_u32 s34, 0
  s_cbranch_scc1 L_ln
  buffer_load_dwordx4 v[48:51], v2, s[36:39], s60 offen offset:0 nt
  buffer_load_dwordx4 v[52:55], v2, s[36:39], s60 offen offset:1024 nt
  buffer_load_dwordx4 v[56:59], v3, s[40:43], s60 offen offset:0 nt
  buffer_load_dwordx4 v[60:63], v3, s[40:43], s60 offen offset:1024 nt
  s_add_u32 s60, s60, 16384
  s_branch L_ln_done
L_ln:
  s_waitcnt vmcnt(5)
  v_lshlrev_b32 v30, 16, v24
  v_and_b32 v31, 0xffff0000, v24
  v_lshlrev_b32 v32, 16, v25
  v_and_b32 v33, 0xffff0000, v25
  v_lshlrev_b32 v34, 16, v26
  v_and_b32 v35, 0xffff0000, v26
  v_lshlrev_b32 v36, 16, v27
  v_and_b32 v37, 0xffff0000, v27
  v_lshlrev_b32 v38, 16, v28
  v_and_b32 v39, 0xffff0000, v28
  v_lshlrev_b32 v40, 16, v29
  v_and_b32 v41, 0xffff0000, v29
  v_pk_add_f32 v[12:13], v[30:31], v[32:33]
  v_pk_add_f32 v[14:15], v[34:35], v[36:37]
  v_pk_add_f32 v[16:17], v[38:39], v[40:41]
  v_pk_add_f32 v[12:13], v[12:13], v[14:15]
  v_pk_add_f32 v[12:13], v[12:13], v[16:17]
  v_add_f32 v14, v12, v13
  s_nop 1
  v_add_f32_dpp v14, v14, v14 quad_perm:[1,0,3,2] row_mask:0xf bank_mask:0xf
  s_nop 1
  v_add_f32_dpp v14, v14, v14 quad_perm:[2,3,0,1] row_mask:0xf bank_mask:0xf
  s_nop 1
  v_add_f32_dpp v14, v14, v14 row_half_mirror row_mask:0xf bank_mask:0xf
  s_nop 1
  v_add_f32_dpp v14, v14, v14 row_mirror row_mask:0xf bank_mask:0xf
  v_mov_b32 v15, v14
  s_nop 1
  v_permlane16_swap_b32 v14, v15
  s_nop 0
  v_add_f32 v14, v14, v15
  v_mov_b32 v15, v14
  s_nop 1
  v_permlane32_swap_b32 v14, v15
  s_nop 0
  v_add_f32 v14, v14, v15
  v_mul_f32 v14, 0xbae38e39, v14
  v_mov_b32 v15, v14
  v_pk_add_f32 v[12:13], v[30:31], v[14:15]
  v_pk_mul_f32 v[16:17], v[12:13], v[12:13]
  v_pk_add_f32 v[12:13], v[32:33], v[14:15]
  v_pk_fma_f32 v[16:17], v[12:13], v[12:13], v[16:17]
  v_pk_add_f32 v[12:13], v[34:35], v[14:15]
  v_pk_fma_f32 v[16:17], v[12:13], v[12:13], v[16:17]
  v_pk_add_f32 v[12:13], v[36:37], v[14:15]
  v_pk_fma_f32 v[16:17], v[12:13], v[12:13], v[16:17]
  v_pk_add_f32 v[12:13], v[38:39], v[14:15]
  v_pk_fma_f32 v[16:17], v[12:13], v[12:13], v[16:17]
  v_pk_add_f32 v[12:13], v[40:41], v[14:15]
  v_pk_fma_f32 v[16:17], v[12:13], v[12:13], v[16:17]
  v_add_f32 v16, v16, v17
  v_cmp_gt_u32 vcc, 48, v1
  s_nop 1
  v_cndmask_b32 v16, 0, v16, vcc
  s_nop 1
  v_add_f32_dpp v16, v16, v16 quad_perm:[1,0,3,2] row_mask:0xf bank_mask:0xf
  s_nop 1
  v_add_f32_dpp v16, v16, v16 quad_perm:[2,3,0,1] row_mask:0xf bank_mask:0xf
  s_nop 1
  v_add_f32_dpp v16, v16, v16 row_half_mirror row_mask:0xf bank_mask:0xf
  s_nop 1
  v_add_f32_dpp v16, v16, v16 row_mirror row_mask:0xf bank_mask:0xf
  v_mov_b32 v17, v16
  s_nop 1
  v_permlane16_swap_b32 v16, v17
  s_nop 0
  v_add_f32 v16, v16, v17
  v_mov_b32 v17, v16
  s_nop 1
  v_permlane32_swap_b32 v16, v17
  s_nop 0
  v_add_f32 v16, v16, v17
  v_mul_f32 v16, 0x3ae38e39, v16
  v_cvt_pk_bf16_f32 v16, 0, v16
  v_add_f32 v16, 0x3727c5ac, v16
  v_cvt_pk_bf16_f32 v16, 0, v16
  v_sqrt_f32 v16, v16
  s_nop 0
  v_cvt_pk_bf16_f32 v16, 0, v16
  v_rcp_f32 v16, v16
  v_cvt_pk_bf16_f32 v14, 0, v14
  v_mov_b32 v15, v14
  v_mov_b32 v17, v16
  v_pk_add_f32 v[30:31], v[30:31], v[14:15]
  v_pk_add_f32 v[32:33], v[32:33], v[14:15]
  v_pk_add_f32 v[34:35], v[34:35], v[14:15]
  v_pk_add_f32 v[36:37], v[36:37], v[14:15]
  v_pk_add_f32 v[38:39], v[38:39], v[14:15]
  v_pk_add_f32 v[40:41], v[40:41], v[14:15]
  v_cvt_pk_bf16_f32 v24, v30, v31
  v_cvt_pk_bf16_f32 v25, v32, v33
  v_cvt_pk_bf16_f32 v26, v34, v35
  v_cvt_pk_bf16_f32 v27, v36, v37
  v_cvt_pk_bf16_f32 v28, v38, v39
  v_cvt_pk_bf16_f32 v29, v40, v41
  v_lshlrev_b32 v30, 16, v24
  v_and_b32 v31, 0xffff0000, v24
  v_lshlrev_b32 v32, 16, v25
  v_and_b32 v33, 0xffff0000, v25
  v_lshlrev_b32 v34, 16, v26
  v_and_b32 v35, 0xffff0000, v26
  v_lshlrev_b32 v36, 16, v27
  v_and_b32 v37, 0xffff0000, v27
  v_lshlrev_b32 v38, 16, v28
  v_and_b32 v39, 0xffff0000, v28
  v_lshlrev_b32 v40, 16, v29
  v_and_b32 v41, 0xffff0000, v29
  v_pk_mul_f32 v[30:31], v[30:31], v[16:17]
  v_pk_mul_f32 v[32:33], v[32:33], v[16:17]
  v_pk_mul_f32 v[34:35], v[34:35], v[16:17]
  v_pk_mul_f32 v[36:37], v[36:37], v[16:17]
  v_pk_mul_f32 v[38:39], v[38:39], v[16:17]
  v_pk_mul_f32 v[40:41], v[40:41], v[16:17]
  v_cvt_pk_bf16_f32 v24, v30, v31
  v_cvt_pk_bf16_f32 v25, v32, v33
  v_cvt_pk_bf16_f32 v26, v34, v35
  v_cvt_pk_bf16_f32 v27, v36, v37
  v_cvt_pk_bf16_f32 v28, v38, v39
  v_cvt_pk_bf16_f32 v29, v40, v41
  v_add_u32 v5, 155392, v5
  s_mov_b32 exec_hi, 0xffff
  ds_write_b64 v5, v[24:25] offset:0
  ds_write_b64 v5, v[26:27] offset:8
  ds_write_b64 v5, v[28:29] offset:16
  s_mov_b32 exec_hi, -1
  buffer_load_dwordx4 v[48:51], v2, s[36:39], s60 offen offset:0 nt
  buffer_load_dwordx4 v[52:55], v2, s[36:39], s60 offen offset:1024 nt
  buffer_load_dwordx4 v[56:59], v3, s[40:43], s60 offen offset:0 nt
  buffer_load_dwordx4 v[60:63], v3, s[40:43], s60 offen offset:1024 nt
  s_add_u32 s60, s60, 16384
  s_waitcnt lgkmcnt(0)
L_ln_done:
  s_mul_i32 s62, s34, 144
  s_add_u32 s62, s62, 155392
  v_add_u32 v45, s62, v45
  s_barrier
  ds_read2_b32 v[84:85], v45 offset0:0 offset1:1
  ds_read2_b32 v[86:87], v45 offset0:2 offset1:3
  ds_read2_b32 v[88:89], v45 offset0:4 offset1:5
  ds_read2_b32 v[90:91], v45 offset0:6 offset1:7
  ds_read_b32 v92, v45 offset:32
  s_waitcnt lgkmcnt(0)
  v_perm_b32 v4, v84, v84, v102
  v_perm_b32 v5, v84, v84, v103
  v_perm_b32 v6, v84, v84, v104
  v_perm_b32 v7, v84, v84, v105
  v_perm_b32 v8, v85, v85, v102
  v_perm_b32 v9, v85, v85, v103
  v_perm_b32 v10, v85, v85, v104
  v_perm_b32 v11, v85, v85, v105
  s_waitcnt vmcnt(4)
  v_mfma_f32_16x16x32_bf16 v[24:27], v[64:67], v[4:7], 0
  v_mfma_f32_16x16x32_bf16 v[28:31], v[64:67], v[8:11], 0
  v_perm_b32 v4, v86, v86, v102
  v_perm_b32 v5, v86, v86, v103
  v_perm_b32 v6, v86, v86, v104
  v_perm_b32 v7, v86, v86, v105
  v_perm_b32 v8, v87, v87, v102
  v_perm_b32 v9, v87, v87, v103
  v_perm_b32 v10, v87, v87, v104
  v_perm_b32 v11, v87, v87, v105
  v_mfma_f32_16x16x32_bf16 v[24:27], v[68:71], v[4:7], v[24:27]
  s_nop 0
  v_mfma_f32_16x16x32_bf16 v[28:31], v[68:71], v[8:11], v[28:31]
  v_perm_b32 v4, v88, v88, v102
  v_perm_b32 v5, v88, v88, v103
  v_perm_b32 v6, v88, v88, v104
  v_perm_b32 v7, v88, v88, v105
  v_perm_b32 v8, v89, v89, v102
  v_perm_b32 v9, v89, v89, v103
  v_perm_b32 v10, v89, v89, v104
  v_perm_b32 v11, v89, v89, v105
  v_mfma_f32_16x16x32_bf16 v[24:27], v[72:75], v[4:7], v[24:27]
  s_nop 0
  v_mfma_f32_16x16x32_bf16 v[28:31], v[72:75], v[8:11], v[28:31]
  v_perm_b32 v4, v90, v90, v102
  v_perm_b32 v5, v90, v90, v103
  v_perm_b32 v6, v90, v90, v104
  v_perm_b32 v7, v90, v90, v105
  v_perm_b32 v8, v91, v91, v102
  v_perm_b32 v9, v91, v91, v103
  v_perm_b32 v10, v91, v91, v104
  v_perm_b32 v11, v91, v91, v105
  v_mfma_f32_16x16x32_bf16 v[24:27], v[76:79], v[4:7], v[24:27]
  s_nop 0
  v_mfma_f32_16x16x32_bf16 v[28:31], v[76:79], v[8:11], v[28:31]
  v_perm_b32 v4, v92, v92, v102
  v_perm_b32 v5, v92, v92, v103
  v_perm_b32 v6, v92, v92, v104
  v_perm_b32 v7, v92, v92, v105
  s_nop 1
  v_mfma_f32_16x16x32_bf16 v[24:27], v[80:83], v[4:7], v[24:27]
  v_lshrrev_b32 v4, 4, v1
  v_lshlrev_b32 v4, 7, v4
  v_and_b32 v5, 7, v1
  v_lshl_add_u32 v4, v5, 2, v4
  s_lshl_b32 s62, s34, 9
  s_add_u32 s62, s62, 139264
  v_add_u32 v4, s62, v4
  s_mov_b32 s96, 0
  s_mov_b32 s97, -1
  v_cndmask_b32 v5, v24, v28, s[96:97]
  v_cndmask_b32 v6, v25, v29, s[96:97]
  v_cndmask_b32 v7, v26, v30, s[96:97]
  v_cndmask_b32 v8, v27, v31, s[96:97]
  s_mov_b32 s96, 0xff0000ff
  s_mov_b32 s97, 0xff0000ff
  s_mov_b64 exec, s[96:97]
  ds_write_b32 v4, v5 offset:0
  ds_write_b32 v4, v6 offset:32
  ds_write_b32 v4, v7 offset:64
  ds_write_b32 v4, v8 offset:96
  s_mov_b64 exec, -1
  s_mov_b32 s44, s28
  s_and_b32 s45, s29, 0xffff
  s_mov_b32 s46, 2097152
  s_mov_b32 s47, 0x20000
  s_waitcnt lgkmcnt(0)
  s_mul_i32 s35, s35, 1664525
  s_add_u32 s35, s35, 1013904223
  s_mov_b32 s90, 100000
  s_barrier
  s_cmp_eq_u32 s34, 0
  s_cbranch_scc0 L_notw0
  v_lshrrev_b32 v4, 5, v1
  v_lshlrev_b32 v4, 11, v4
  v_and_b32 v5, 31, v1
  v_lshl_add_u32 v4, v5, 2, v4
  v_add_u32 v4, 139264, v4
  ds_read_b32 v24, v4 offset:0
  ds_read_b32 v25, v4 offset:128
  ds_read_b32 v26, v4 offset:256
  ds_read_b32 v27, v4 offset:384
  ds_read_b32 v28, v4 offset:512
  ds_read_b32 v29, v4 offset:640
  ds_read_b32 v30, v4 offset:768
  ds_read_b32 v31, v4 offset:896
  ds_read_b32 v32, v4 offset:1024
  ds_read_b32 v33, v4 offset:1152
  ds_read_b32 v34, v4 offset:1280
  ds_read_b32 v35, v4 offset:1408
  ds_read_b32 v36, v4 offset:1536
  ds_read_b32 v37, v4 offset:1664
  ds_read_b32 v38, v4 offset:1792
  ds_read_b32 v39, v4 offset:1920
  s_waitcnt lgkmcnt(0)
  v_add_f32 v24, v24, v25
  v_add_f32 v26, v26, v27
  v_add_f32 v28, v28, v29
  v_add_f32 v30, v30, v31
  v_add_f32 v32, v32, v33
  v_add_f32 v34, v34, v35
  v_add_f32 v36, v36, v37
  v_add_f32 v38, v38, v39
  v_add_f32 v24, v24, v26
  v_add_f32 v28, v28, v30
  v_add_f32 v32, v32, v34
  v_add_f32 v36, v36, v38
  v_add_f32 v24, v24, v28
  v_add_f32 v32, v32, v36
  v_add_f32 v24, v24, v32
  v_mov_b32 v25, v24
  s_nop 1
  v_permlane32_swap_b32 v24, v25
  s_nop 0
  v_add_f32 v24, v24, v25
  v_cvt_pk_bf16_f32 v24, 0, v24
  v_mov_b32 v25, s35
  s_lshl_b32 s62, s33, 8
  s_lshl_b32 s63, s32, 5
  s_add_u32 s62, s62, s63
  s_lshl_b32 s62, s62, 3
  s_add_u32 s62, s62, 983040
  v_lshlrev_b32 v5, 3, v5
  s_mov_b32 exec_hi, 0
  buffer_store_dwordx2 v[24:25], v5, s[44:47], s62 offen sc1
  s_mov_b32 exec_hi, -1
  s_cmp_eq_u32 s77, 0
  s_cbranch_scc0 L_notw0
  s_lshl_b32 s62, s76, 7
  s_add_u32 s62, s62, 98304
  v_mov_b32 v24, 0
  v_mov_b32 v26, 0
  v_mov_b32 v27, s35
  s_mov_b64 exec, 1
  buffer_store_dwordx2 v[26:27], v24, s[44:47], s62 offen sc1
  s_mov_b64 exec, -1
L_notw0:
  s_mul_i32 s62, s31, 576
  s_mul_i32 s63, s32, 72
  s_add_u32 s62, s62, s63
  s_mov_b32 s48, s22
  s_and_b32 s49, s23, 0xffff
  s_mov_b32 s50, 9216
  s_mov_b32 s51, 0x20000
  v_lshlrev_b32 v16, 1, v1
  buffer_load_ushort v126, v16, s[48:51], s62 offen nt
  s_and_b32 s6, s62, 15
  s_andn2_b32 s62, s62, 15
  s_mul_i32 s63, s34, 663552
  s_add_u32 s93, s62, s63
  s_mov_b32 s56, s20
  s_and_b32 s57, s21, 0xffff
  s_mov_b32 s58, 5308416
  s_mov_b32 s59, 0x20000
  s_mul_i32 s100, s34, 6144
  s_movk_i32 s101, 13108
  s_movk_i32 s7, 9136
  v_mov_b32 v46, v1
  v_and_b32 v16, 1, v1
  v_cmp_eq_u32 vcc, 1, v16
  v_mov_b32 v16, 0xffff
  v_mov_b32 v17, 0xffff0000
  v_cndmask_b32 v16, v16, v17, vcc
  v_cndmask_b32 v8, 0, v16, s[66:67]
  v_cndmask_b32 v9, 0, v16, s[68:69]
  v_cndmask_b32 v10, 0, v16, s[70:71]
  v_cndmask_b32 v11, 0, v16, s[72:73]
  v_mov_b32 v12, 0xff800000
  v_mov_b32 v14, 0xff800000
  v_mov_b32 v13, 0
  v_mov_b32 v20, 0
  v_mov_b32 v21, 0
  v_mov_b32 v22, 0
  v_mov_b32 v23, 0
  s_cmp_lt_u32 s34, 4
  s_cbranch_scc1 L_nobonus
  s_sub_u32 s62, s34, 4
  s_mul_i32 s62, s62, 8192
  s_lshl_b32 s63, s77, 20
  s_add_u32 s62, s62, s63
  buffer_load_dwordx4 v[164:167], v2, s[36:39], s62 offen offset:0 nt
  buffer_load_dwordx4 v[168:171], v2, s[36:39], s62 offen offset:1024 nt
  buffer_load_dwordx4 v[172:175], v3, s[40:43], s62 offen offset:0 nt
  buffer_load_dwordx4 v[176:179], v3, s[40:43], s62 offen offset:1024 nt
  s_add_u32 s62, s62, 2048
  buffer_load_dwordx4 v[180:183], v2, s[36:39], s62 offen offset:0 nt
  buffer_load_dwordx4 v[184:187], v2, s[36:39], s62 offen offset:1024 nt
  buffer_load_dwordx4 v[188:191], v3, s[40:43], s62 offen offset:0 nt
  buffer_load_dwordx4 v[192:195], v3, s[40:43], s62 offen offset:1024 nt
  s_add_u32 s62, s62, 2048
  buffer_load_dwordx4 v[196:199], v2, s[36:39], s62 offen offset:0 nt
  buffer_load_dwordx4 v[200:203], v2, s[36:39], s62 offen offset:1024 nt
  buffer_load_dwordx4 v[204:207], v3, s[40:43], s62 offen offset:0 nt
  buffer_load_dwordx4 v[208:211], v3, s[40:43], s62 offen offset:1024 nt
  s_add_u32 s62, s62, 2048
  buffer_load_dwordx4 v[212:215], v2, s[36:39], s62 offen offset:0 nt
  buffer_load_dwordx4 v[216:219], v2, s[36:39], s62 offen offset:1024 nt
  buffer_load_dwordx4 v[220:223], v3, s[40:43], s62 offen offset:0 nt
  buffer_load_dwordx4 v[224:227], v3, s[40:43], s62 offen offset:1024 nt
L_nobonus:
  s_cmp_lt_u32 s34, 4
  s_cbranch_scc0 L_pro_join
  s_lshl_b32 s62, s76, 11
  s_add_u32 s62, s62, 983040
  v_lshlrev_b32 v4, 3, v0
L_gather_q:
  buffer_load_dwordx2 v[6:7], v4, s[44:47], s62 offen sc1
  s_waitcnt vmcnt(0)
  v_cmp_ne_u32 vcc, s35, v7
  s_cbranch_vccz L_q_ok
  s_sub_u32 s90, s90, 1
  s_cmp_eq_u32 s90, 0
  s_cbranch_scc1 L_q_ok
  s_sleep 1
  s_branch L_gather_q
L_q_ok:
  v_lshlrev_b32 v4, 1, v0
  v_add_u32 v4, 149504, v4
  ds_write_b16_d16_hi v4, v6
L_pro_join:
  s_waitcnt lgkmcnt(0)
  s_barrier
  v_bfe_u32 v15, v1, 3, 1
  v_lshlrev_b32 v15, 8, v15
  v_lshrrev_b32 v16, 4, v1
  v_lshl_add_u32 v15, v16, 6, v15
  v_and_b32 v16, 3, v1
  v_lshl_add_u32 v15, v16, 4, v15
  v_add_u32 v15, 149504, v15
  ds_read_b128 v[4:7], v15
  s_waitcnt lgkmcnt(0)
  s_cmp_lt_u32 s34, 4
  s_cbranch_scc1 L_peel_lo
  s_waitcnt vmcnt(17)
  v_mfma_f32_16x16x32_bf16 v[24:27], v[48:51], v[4:7], 0
  v_mfma_f32_16x16x32_bf16 v[28:31], v[52:55], v[4:7], 0
  buffer_load_dwordx4 v[48:51], v2, s[36:39], s60 offen offset:0 nt
  buffer_load_dwordx4 v[52:55], v2, s[36:39], s60 offen offset:1024 nt
  s_nop 4
  v_mov_b32_dpp v40, v24 quad_perm:[0,0,0,0] row_mask:0xf bank_mask:0xf
  v_mov_b32_dpp v41, v28 quad_perm:[0,0,0,0] row_mask:0xf bank_mask:0xf
  v_mov_b32_dpp v44, v26 quad_perm:[2,2,2,2] row_mask:0xf bank_mask:0xf
  v_mov_b32_dpp v45, v30 quad_perm:[2,2,2,2] row_mask:0xf bank_mask:0xf
  v_add_f32_dpp v40, v25, v40 quad_perm:[1,1,1,1] row_mask:0xf bank_mask:0xf
  v_add_f32_dpp v41, v29, v41 quad_perm:[1,1,1,1] row_mask:0xf bank_mask:0xf
  v_add_f32_dpp v44, v27, v44 quad_perm:[3,3,3,3] row_mask:0xf bank_mask:0xf
  v_add_f32_dpp v45, v31, v45 quad_perm:[3,3,3,3] row_mask:0xf bank_mask:0xf
  v_add_f32 v40, v40, v44
  v_add_f32 v41, v41, v45
  v_cvt_pk_bf16_f32 v40, 0, v40
  v_cvt_pk_bf16_f32 v41, 0, v41
  v_mul_f32 v40, s92, v40
  v_mul_f32 v41, s92, v41
  v_cvt_pk_bf16_f32 v40, 0, v40
  v_cvt_pk_bf16_f32 v41, 0, v41
  v_max3_f32 v15, v12, v40, v41
  v_mov_b32 v16, v15
  s_nop 1
  v_permlane16_swap_b32 v15, v16
  s_nop 0
  v_max_f32 v15, v15, v16
  v_mov_b32 v16, v15
  s_nop 1
  v_permlane32_swap_b32 v15, v16
  s_nop 0
  v_max_f32 v15, v15, v16
  v_mul_f32 v16, s91, v15
  v_mov_b32 v12, v15
  v_sub_f32 v17, v14, v16
  v_fma_f32 v40, v40, s91, -v16
  v_fma_f32 v41, v41, s91, -v16
  v_exp_f32 v17, v17
  v_exp_f32 v40, v40
  v_exp_f32 v41, v41
  v_mov_b32 v14, v16
  v_fma_f32 v13, v13, v17, v40
  v_mul_f32 v20, v20, v17
  v_mul_f32 v21, v21, v17
  v_mul_f32 v22, v22, v17
  v_mul_f32 v23, v23, v17
  v_add_f32 v13, v13, v41
  v_cvt_pk_bf16_f32 v40, v40, v40
  v_cvt_pk_bf16_f32 v41, v41, v41
  v_and_b32 v24, v40, v8
  v_and_b32 v25, v40, v9
  v_and_b32 v26, v40, v10
  v_and_b32 v27, v40, v11
  v_and_b32 v28, v41, v8
  v_and_b32 v29, v41, v9
  v_and_b32 v30, v41, v10
  v_and_b32 v31, v41, v11
  v_mfma_f32_16x16x32_bf16 v[20:23], v[56:59], v[24:27], v[20:23]
  s_nop 0
  v_mfma_f32_16x16x32_bf16 v[20:23], v[60:63], v[28:31], v[20:23]
  buffer_load_dwordx4 v[56:59], v3, s[40:43], s60 offen offset:0 nt
  buffer_load_dwordx4 v[60:63], v3, s[40:43], s60 offen offset:1024 nt
  s_add_u32 s60, s60, 16384
  s_waitcnt vmcnt(16)
  v_mfma_f32_16x16x32_bf16 v[24:27], v[164:167], v[4:7], 0
  v_mfma_f32_16x16x32_bf16 v[28:31], v[168:171], v[4:7], 0
  s_nop 6
  v_mov_b32_dpp v40, v24 quad_perm:[0,0,0,0] row_mask:0xf bank_mask:0xf
  v_mov_b32_dpp v41, v28 quad_perm:[0,0,0,0] row_mask:0xf bank_mask:0xf
  v_mov_b32_dpp v44, v26 quad_perm:[2,2,2,2] row_mask:0xf bank_mask:0xf
  v_mov_b32_dpp v45, v30 quad_perm:[2,2,2,2] row_mask:0xf bank_mask:0xf
  v_add_f32_dpp v40, v25, v40 quad_perm:[1,1,1,1] row_mask:0xf bank_mask:0xf
  v_add_f32_dpp v41, v29, v41 quad_perm:[1,1,1,1] row_mask:0xf bank_mask:0xf
  v_add_f32_dpp v44, v27, v44 quad_perm:[3,3,3,3] row_mask:0xf bank_mask:0xf
  v_add_f32_dpp v45, v31, v45 quad_perm:[3,3,3,3] row_mask:0xf bank_mask:0xf
  v_add_f32 v40, v40, v44
  v_add_f32 v41, v41, v45
  v_cvt_pk_bf16_f32 v40, 0, v40
  v_cvt_pk_bf16_f32 v41, 0, v41
  v_mul_f32 v40, s92, v40
  v_mul_f32 v41, s92, v41
  v_cvt_pk_bf16_f32 v40, 0, v40
  v_cvt_pk_bf16_f32 v41, 0, v41
  v_max3_f32 v15, v12, v40, v41
  v_mov_b32 v16, v15
  s_nop 1
  v_permlane16_swap_b32 v15, v16
  s_nop 0
  v_max_f32 v15, v15, v16
  v_mov_b32 v16, v15
  s_nop 1
  v_permlane32_swap_b32 v15, v16
  s_nop 0
  v_max_f32 v15, v15, v16
  v_mul_f32 v16, s91, v15
  v_mov_b32 v12, v15
  v_sub_f32 v17, v14, v16
  v_fma_f32 v40, v40, s91, -v16
  v_fma_f32 v41, v41, s91, -v16
  v_exp_f32 v17, v17
  v_exp_f32 v40, v40
  v_exp_f32 v41, v41
  v_mov_b32 v14, v16
  v_fma_f32 v13, v13, v17, v40
  v_mul_f32 v20, v20, v17
  v_mul_f32 v21, v21, v17
  v_mul_f32 v22, v22, v17
  v_mul_f32 v23, v23, v17
  v_add_f32 v13, v13, v41
  v_cvt_pk_bf16_f32 v40, v40, v40
  v_cvt_pk_bf16_f32 v41, v41, v41
  v_and_b32 v24, v40, v8
  v_and_b32 v25, v40, v9
  v_and_b32 v26, v40, v10
  v_and_b32 v27, v40, v11
  v_and_b32 v28, v41, v8
  v_and_b32 v29, v41, v9
  v_and_b32 v30, v41, v10
  v_and_b32 v31, v41, v11
  v_mfma_f32_16x16x32_bf16 v[20:23], v[172:175], v[24:27], v[20:23]
  s_nop 0
  v_mfma_f32_16x16x32_bf16 v[20:23], v[176:179], v[28:31], v[20:23]
  s_waitcnt vmcnt(12)
  v_mfma_f32_16x16x32_bf16 v[24:27], v[180:183], v[4:7], 0
  v_mfma_f32_16x16x32_bf16 v[28:31], v[184:187], v[4:7], 0
  s_nop 6
  v_mov_b32_dpp v40, v24 quad_perm:[0,0,0,0] row_mask:0xf bank_mask:0xf
  v_mov_b32_dpp v41, v28 quad_perm:[0,0,0,0] row_mask:0xf bank_mask:0xf
  v_mov_b32_dpp v44, v26 quad_perm:[2,2,2,2] row_mask:0xf bank_mask:0xf
  v_mov_b32_dpp v45, v30 quad_perm:[2,2,2,2] row_mask:0xf bank_mask:0xf
  v_add_f32_dpp v40, v25, v40 quad_perm:[1,1,1,1] row_mask:0xf bank_mask:0xf
  v_add_f32_dpp v41, v29, v41 quad_perm:[1,1,1,1] row_mask:0xf bank_mask:0xf
  v_add_f32_dpp v44, v27, v44 quad_perm:[3,3,3,3] row_mask:0xf bank_mask:0xf
  v_add_f32_dpp v45, v31, v45 quad_perm:[3,3,3,3] row_mask:0xf bank_mask:0xf
  v_add_f32 v40, v40, v44
  v_add_f32 v41, v41, v45
  v_cvt_pk_bf16_f32 v40, 0, v40
  v_cvt_pk_bf16_f32 v41, 0, v41
  v_mul_f32 v40, s92, v40
  v_mul_f32 v41, s92, v41
  v_cvt_pk_bf16_f32 v40, 0, v40
  v_cvt_pk_bf16_f32 v41, 0, v41
  v_max3_f32 v15, v12, v40, v41
  v_mov_b32 v16, v15
  s_nop 1
  v_permlane16_swap_b32 v15, v16
  s_nop 0
  v_max_f32 v15, v15, v16
  v_mov_b32 v16, v15
  s_nop 1
  v_permlane32_swap_b32 v15, v16
  s_nop 0
  v_max_f32 v15, v15, v16
  v_mul_f32 v16, s91, v15
  v_mov_b32 v12, v15
  v_sub_f32 v17, v14, v16
  v_fma_f32 v40, v40, s91, -v16
  v_fma_f32 v41, v41, s91, -v16
  v_exp_f32 v17, v17
  v_exp_f32 v40, v40
  v_exp_f32 v41, v41
  v_mov_b32 v14, v16
  v_fma_f32 v13, v13, v17, v40
  v_mul_f32 v20, v20, v17
  v_mul_f32 v21, v21, v17
  v_mul_f32 v22, v22, v17
  v_mul_f32 v23, v23, v17
  v_add_f32 v13, v13, v41
  v_cvt_pk_bf16_f32 v40, v40, v40
  v_cvt_pk_bf16_f32 v41, v41, v41
  v_and_b32 v24, v40, v8
  v_and_b32 v25, v40, v9
  v_and_b32 v26, v40, v10
  v_and_b32 v27, v40, v11
  v_and_b32 v28, v41, v8
  v_and_b32 v29, v41, v9
  v_and_b32 v30, v41, v10
  v_and_b32 v31, v41, v11
  v_mfma_f32_16x16x32_bf16 v[20:23], v[188:191], v[24:27], v[20:23]
  s_nop 0
  v_mfma_f32_16x16x32_bf16 v[20:23], v[192:195], v[28:31], v[20:23]
  s_waitcnt vmcnt(8)
  v_mfma_f32_16x16x32_bf16 v[24:27], v[196:199], v[4:7], 0
  v_mfma_f32_16x16x32_bf16 v[28:31], v[200:203], v[4:7], 0
  s_nop 6
  v_mov_b32_dpp v40, v24 quad_perm:[0,0,0,0] row_mask:0xf bank_mask:0xf
  v_mov_b32_dpp v41, v28 quad_perm:[0,0,0,0] row_mask:0xf bank_mask:0xf
  v_mov_b32_dpp v44, v26 quad_perm:[2,2,2,2] row_mask:0xf bank_mask:0xf
  v_mov_b32_dpp v45, v30 quad_perm:[2,2,2,2] row_mask:0xf bank_mask:0xf
  v_add_f32_dpp v40, v25, v40 quad_perm:[1,1,1,1] row_mask:0xf bank_mask:0xf
  v_add_f32_dpp v41, v29, v41 quad_perm:[1,1,1,1] row_mask:0xf bank_mask:0xf
  v_add_f32_dpp v44, v27, v44 quad_perm:[3,3,3,3] row_mask:0xf bank_mask:0xf
  v_add_f32_dpp v45, v31, v45 quad_perm:[3,3,3,3] row_mask:0xf bank_mask:0xf
  v_add_f32 v40, v40, v44
  v_add_f32 v41, v41, v45
  v_cvt_pk_bf16_f32 v40, 0, v40
  v_cvt_pk_bf16_f32 v41, 0, v41
  v_mul_f32 v40, s92, v40
  v_mul_f32 v41, s92, v41
  v_cvt_pk_bf16_f32 v40, 0, v40
  v_cvt_pk_bf16_f32 v41, 0, v41
  v_max3_f32 v15, v12, v40, v41
  v_mov_b32 v16, v15
  s_nop 1
  v_permlane16_swap_b32 v15, v16
  s_nop 0
  v_max_f32 v15, v15, v16
  v_mov_b32 v16, v15
  s_nop 1
  v_permlane32_swap_b32 v15, v16
  s_nop 0
  v_max_f32 v15, v15, v16
  v_mul_f32 v16, s91, v15
  v_mov_b32 v12, v15
  v_sub_f32 v17, v14, v16
  v_fma_f32 v40, v40, s91, -v16
  v_fma_f32 v41, v41, s91, -v16
  v_exp_f32 v17, v17
  v_exp_f32 v40, v40
  v_exp_f32 v41, v41
  v_mov_b32 v14, v16
  v_fma_f32 v13, v13, v17, v40
  v_mul_f32 v20, v20, v17
  v_mul_f32 v21, v21, v17
  v_mul_f32 v22, v22, v17
  v_mul_f32 v23, v23, v17
  v_add_f32 v13, v13, v41
  v_cvt_pk_bf16_f32 v40, v40, v40
  v_cvt_pk_bf16_f32 v41, v41, v41
  v_and_b32 v24, v40, v8
  v_and_b32 v25, v40, v9
  v_and_b32 v26, v40, v10
  v_and_b32 v27, v40, v11
  v_and_b32 v28, v41, v8
  v_and_b32 v29, v41, v9
  v_and_b32 v30, v41, v10
  v_and_b32 v31, v41, v11
  v_mfma_f32_16x16x32_bf16 v[20:23], v[204:207], v[24:27], v[20:23]
  s_nop 0
  v_mfma_f32_16x16x32_bf16 v[20:23], v[208:211], v[28:31], v[20:23]
  s_waitcnt vmcnt(4)
  v_mfma_f32_16x16x32_bf16 v[24:27], v[212:215], v[4:7], 0
  v_mfma_f32_16x16x32_bf16 v[28:31], v[216:219], v[4:7], 0
  s_nop 6
  v_mov_b32_dpp v40, v24 quad_perm:[0,0,0,0] row_mask:0xf bank_mask:0xf
  v_mov_b32_dpp v41, v28 quad_perm:[0,0,0,0] row_mask:0xf bank_mask:0xf
  v_mov_b32_dpp v44, v26 quad_perm:[2,2,2,2] row_mask:0xf bank_mask:0xf
  v_mov_b32_dpp v45, v30 quad_perm:[2,2,2,2] row_mask:0xf bank_mask:0xf
  v_add_f32_dpp v40, v25, v40 quad_perm:[1,1,1,1] row_mask:0xf bank_mask:0xf
  v_add_f32_dpp v41, v29, v41 quad_perm:[1,1,1,1] row_mask:0xf bank_mask:0xf
  v_add_f32_dpp v44, v27, v44 quad_perm:[3,3,3,3] row_mask:0xf bank_mask:0xf
  v_add_f32_dpp v45, v31, v45 quad_perm:[3,3,3,3] row_mask:0xf bank_mask:0xf
  v_add_f32 v40, v40, v44
  v_add_f32 v41, v41, v45
  v_cvt_pk_bf16_f32 v40, 0, v40
  v_cvt_pk_bf16_f32 v41, 0, v41
  v_mul_f32 v40, s92, v40
  v_mul_f32 v41, s92, v41
  v_cvt_pk_bf16_f32 v40, 0, v40
  v_cvt_pk_bf16_f32 v41, 0, v41
  v_max3_f32 v15, v12, v40, v41
  v_mov_b32 v16, v15
  s_nop 1
  v_permlane16_swap_b32 v15, v16
  s_nop 0
  v_max_f32 v15, v15, v16
  v_mov_b32 v16, v15
  s_nop 1
  v_permlane32_swap_b32 v15, v16
  s_nop 0
  v_max_f32 v15, v15, v16
  v_mul_f32 v16, s91, v15
  v_mov_b32 v12, v15
  v_sub_f32 v17, v14, v16
  v_fma_f32 v40, v40, s91, -v16
  v_fma_f32 v41, v41, s91, -v16
  v_exp_f32 v17, v17
  v_exp_f32 v40, v40
  v_exp_f32 v41, v41
  v_mov_b32 v14, v16
  v_fma_f32 v13, v13, v17, v40
  v_mul_f32 v20, v20, v17
  v_mul_f32 v21, v21, v17
  v_mul_f32 v22, v22, v17
  v_mul_f32 v23, v23, v17
  v_add_f32 v13, v13, v41
  v_cvt_pk_bf16_f32 v40, v40, v40
  v_cvt_pk_bf16_f32 v41, v41, v41
  v_and_b32 v24, v40, v8
  v_and_b32 v25, v40, v9
  v_and_b32 v26, v40, v10
  v_and_b32 v27, v40, v11
  v_and_b32 v28, v41, v8
  v_and_b32 v29, v41, v9
  v_and_b32 v30, v41, v10
  v_and_b32 v31, v41, v11
  v_mfma_f32_16x16x32_bf16 v[20:23], v[220:223], v[24:27], v[20:23]
  s_nop 0
  v_mfma_f32_16x16x32_bf16 v[20:23], v[224:227], v[28:31], v[20:23]
  s_branch L_peel_done
L_peel_lo:
  s_waitcnt vmcnt(1)
  v_mfma_f32_16x16x32_bf16 v[24:27], v[48:51], v[4:7], 0
  v_mfma_f32_16x16x32_bf16 v[28:31], v[52:55], v[4:7], 0
  buffer_load_dwordx4 v[48:51], v2, s[36:39], s60 offen offset:0 nt
  buffer_load_dwordx4 v[52:55], v2, s[36:39], s60 offen offset:1024 nt
  s_nop 4
  v_mov_b32_dpp v40, v24 quad_perm:[0,0,0,0] row_mask:0xf bank_mask:0xf
  v_mov_b32_dpp v41, v28 quad_perm:[0,0,0,0] row_mask:0xf bank_mask:0xf
  v_mov_b32_dpp v44, v26 quad_perm:[2,2,2,2] row_mask:0xf bank_mask:0xf
  v_mov_b32_dpp v45, v30 quad_perm:[2,2,2,2] row_mask:0xf bank_mask:0xf
  v_add_f32_dpp v40, v25, v40 quad_perm:[1,1,1,1] row_mask:0xf bank_mask:0xf
  v_add_f32_dpp v41, v29, v41 quad_perm:[1,1,1,1] row_mask:0xf bank_mask:0xf
  v_add_f32_dpp v44, v27, v44 quad_perm:[3,3,3,3] row_mask:0xf bank_mask:0xf
  v_add_f32_dpp v45, v31, v45 quad_perm:[3,3,3,3] row_mask:0xf bank_mask:0xf
  v_add_f32 v40, v40, v44
  v_add_f32 v41, v41, v45
  v_cvt_pk_bf16_f32 v40, 0, v40
  v_cvt_pk_bf16_f32 v41, 0, v41
  v_mul_f32 v40, s92, v40
  v_mul_f32 v41, s92, v41
  v_cvt_pk_bf16_f32 v40, 0, v40
  v_cvt_pk_bf16_f32 v41, 0, v41
  v_max3_f32 v15, v12, v40, v41
  v_mov_b32 v16, v15
  s_nop 1
  v_permlane16_swap_b32 v15, v16
  s_nop 0
  v_max_f32 v15, v15, v16
  v_mov_b32 v16, v15
  s_nop 1
  v_permlane32_swap_b32 v15, v16
  s_nop 0
  v_max_f32 v15, v15, v16
  v_mul_f32 v16, s91, v15
  v_mov_b32 v12, v15
  v_sub_f32 v17, v14, v16
  v_fma_f32 v40, v40, s91, -v16
  v_fma_f32 v41, v41, s91, -v16
  v_exp_f32 v17, v17
  v_exp_f32 v40, v40
  v_exp_f32 v41, v41
  v_mov_b32 v14, v16
  v_fma_f32 v13, v13, v17, v40
  v_mul_f32 v20, v20, v17
  v_mul_f32 v21, v21, v17
  v_mul_f32 v22, v22, v17
  v_mul_f32 v23, v23, v17
  v_add_f32 v13, v13, v41
  v_cvt_pk_bf16_f32 v40, v40, v40
  v_cvt_pk_bf16_f32 v41, v41, v41
  v_and_b32 v24, v40, v8
  v_and_b32 v25, v40, v9
  v_and_b32 v26, v40, v10
  v_and_b32 v27, v40, v11
  v_and_b32 v28, v41, v8
  v_and_b32 v29, v41, v9
  v_and_b32 v30, v41, v10
  v_and_b32 v31, v41, v11
  v_mfma_f32_16x16x32_bf16 v[20:23], v[56:59], v[24:27], v[20:23]
  s_nop 0
  v_mfma_f32_16x16x32_bf16 v[20:23], v[60:63], v[28:31], v[20:23]
  buffer_load_dwordx4 v[56:59], v3, s[40:43], s60 offen offset:0 nt
  buffer_load_dwordx4 v[60:63], v3, s[40:43], s60 offen offset:1024 nt
  s_add_u32 s60, s60, 16384
L_peel_done:
  s_mov_b32 s61, 17
L_loopA:
  s_cmp_eq_u32 s61, 11
  s_cbranch_scc0 L_noswitch
  s_cmp_lt_u32 s34, 4
  s_cselect_b32 s56, s16, s24
  s_cselect_b32 s57, s17, s25
  s_mov_b32 s96, 4718592
  s_cselect_b32 s58, s96, 5308416
  s_and_b32 s57, s57, 0xffff
  s_mov_b32 s59, 0x20000
  s_lshl_b32 s62, s31, 8
  s_lshl_b32 s63, s34, 6
  s_add_u32 s62, s62, s63
  s_mul_i32 s63, s31, 288
  s_mul_i32 s64, s34, 72
  s_add_u32 s63, s63, s64
  s_sub_u32 s63, s63, 288
  s_cmp_lt_u32 s34, 4
  s_cselect_b32 s62, s62, s63
  s_mul_i32 s62, s62, 1152
  s_mul_i32 s63, s32, 144
  s_add_u32 s93, s62, s63
  s_mul_i32 s100, s34, 11264
  s_add_u32 s100, s100, 49152
  s_movk_i32 s101, 7282
  s_movk_i32 s7, 1008
  v_mov_b32 v46, v1
L_noswitch:
  s_waitcnt vmcnt(2)
  v_mfma_f32_16x16x32_bf16 v[24:27], v[48:51], v[4:7], 0
  v_mfma_f32_16x16x32_bf16 v[28:31], v[52:55], v[4:7], 0
  v_mul_u32_u24 v47, s101, v46
  v_lshrrev_b32 v47, 16, v47
  v_mul_u32_u24 v47, s7, v47
  v_lshl_add_u32 v47, v46, 4, v47
  s_mov_b32 m0, s100
  v_add_u32 v46, 64, v46
  buffer_load_dwordx4 v47, s[56:59], s93 offen  lds
  s_add_u32 s100, s100, 1024
  buffer_load_dwordx4 v[48:51], v2, s[36:39], s60 offen offset:0 nt
  buffer_load_dwordx4 v[52:55], v2, s[36:39], s60 offen offset:1024 nt
  v_mov_b32_dpp v40, v24 quad_perm:[0,0,0,0] row_mask:0xf bank_mask:0xf
  v_mov_b32_dpp v41, v28 quad_perm:[0,0,0,0] row_mask:0xf bank_mask:0xf
  v_mov_b32_dpp v44, v26 quad_perm:[2,2,2,2] row_mask:0xf bank_mask:0xf
  v_mov_b32_dpp v45, v30 quad_perm:[2,2,2,2] row_mask:0xf bank_mask:0xf
  v_add_f32_dpp v40, v25, v40 quad_perm:[1,1,1,1] row_mask:0xf bank_mask:0xf
  v_add_f32_dpp v41, v29, v41 quad_perm:[1,1,1,1] row_mask:0xf bank_mask:0xf
  v_add_f32_dpp v44, v27, v44 quad_perm:[3,3,3,3] row_mask:0xf bank_mask:0xf
  v_add_f32_dpp v45, v31, v45 quad_perm:[3,3,3,3] row_mask:0xf bank_mask:0xf
  v_add_f32 v40, v40, v44
  v_add_f32 v41, v41, v45
  v_cvt_pk_bf16_f32 v40, 0, v40
  v_cvt_pk_bf16_f32 v41, 0, v41
  v_mul_f32 v40, s92, v40
  v_mul_f32 v41, s92, v41
  v_cvt_pk_bf16_f32 v40, 0, v40
  v_cvt_pk_bf16_f32 v41, 0, v41
  v_max3_f32 v15, v12, v40, v41
  v_mov_b32 v16, v15
  s_nop 1
  v_permlane16_swap_b32 v15, v16
  s_nop 0
  v_max_f32 v15, v15, v16
  v_mov_b32 v16, v15
  s_nop 1
  v_permlane32_swap_b32 v15, v16
  s_nop 0
  v_max_f32 v15, v15, v16
  v_mul_f32 v16, s91, v15
  v_mov_b32 v12, v15
  v_sub_f32 v17, v14, v16
  v_fma_f32 v40, v40, s91, -v16
  v_fma_f32 v41, v41, s91, -v16
  v_exp_f32 v17, v17
  v_exp_f32 v40, v40
  v_exp_f32 v41, v41
  v_mov_b32 v14, v16
  v_fma_f32 v13, v13, v17, v40
  v_mul_f32 v20, v20, v17
  v_mul_f32 v21, v21, v17
  v_mul_f32 v22, v22, v17
  v_mul_f32 v23, v23, v17
  v_add_f32 v13, v13, v41
  v_cvt_pk_bf16_f32 v40, v40, v40
  v_cvt_pk_bf16_f32 v41, v41, v41
  v_and_b32 v24, v40, v8
  v_and_b32 v25, v40, v9
  v_and_b32 v26, v40, v10
  v_and_b32 v27, v40, v11
  v_and_b32 v28, v41, v8
  v_and_b32 v29, v41, v9
  v_and_b32 v30, v41, v10
  v_and_b32 v31, v41, v11
  s_waitcnt vmcnt(2)
  v_mfma_f32_16x16x32_bf16 v[20:23], v[56:59], v[24:27], v[20:23]
  v_mfma_f32_16x16x32_bf16 v[20:23], v[60:63], v[28:31], v[20:23]
  buffer_load_dwordx4 v[56:59], v3, s[40:43], s60 offen offset:0 nt
  buffer_load_dwordx4 v[60:63], v3, s[40:43], s60 offen offset:1024 nt
  s_add_u32 s60, s60, 16384
  s_sub_u32 s61, s61, 1
  s_cmp_lg_u32 s61, 0
  s_cbranch_scc1 L_loopA
  v_lshrrev_b32 v24, 4, v1
  v_mul_u32_u24 v24, 1440, v24
  v_and_b32 v25, 15, v1
  v_min_u32 v25, 8, v25
  v_lshl_add_u32 v24, v25, 3, v24
  s_mul_i32 s62, s34, 6144
  s_add_u32 s62, s62, s6
  v_add_u32 v24, s62, v24
  ds_read_b64 v[164:165], v24 offset:0
  ds_read_b64 v[166:167], v24 offset:80
  ds_read_b64 v[168:169], v24 offset:160
  ds_read_b64 v[170:171], v24 offset:240
  ds_read_b64 v[172:173], v24 offset:320
  ds_read_b64 v[174:175], v24 offset:400
  ds_read_b64 v[176:177], v24 offset:480
  ds_read_b64 v[178:179], v24 offset:560
  ds_read_b64 v[180:181], v24 offset:640
  ds_read_b64 v[182:183], v24 offset:720
  ds_read_b64 v[184:185], v24 offset:800
  ds_read_b64 v[186:187], v24 offset:880
  ds_read_b64 v[188:189], v24 offset:960
  ds_read_b64 v[190:191], v24 offset:1040
  ds_read_b64 v[192:193], v24 offset:1120
  ds_read_b64 v[194:195], v24 offset:1200
  ds_read_b64 v[196:197], v24 offset:1280
  ds_read_b64 v[198:199], v24 offset:1360
  v_perm_b32 v200, v84, v84, v106
  v_perm_b32 v201, v84, v84, v107
  v_perm_b32 v202, v84, v84, v108
  v_perm_b32 v203, v84, v84, v109
  v_perm_b32 v204, v85, v85, v106
  v_perm_b32 v205, v85, v85, v107
  s_waitcnt lgkmcnt(0)
  v_mfma_f32_16x16x16_bf16 v[32:35], v[164:165], v[200:201], 0
  v_perm_b32 v206, v85, v85, v108
  v_perm_b32 v207, v85, v85, v109
  v_mfma_f32_16x16x16_bf16 v[32:35], v[166:167], v[202:203], v[32:35]
  v_perm_b32 v200, v86, v86, v106
  v_perm_b32 v201, v86, v86, v107
  v_mfma_f32_16x16x16_bf16 v[32:35], v[168:169], v[204:205], v[32:35]
  v_perm_b32 v202, v86, v86, v108
  v_perm_b32 v203, v86, v86, v109
  v_mfma_f32_16x16x16_bf16 v[32:35], v[170:171], v[206:207], v[32:35]
  v_perm_b32 v204, v87, v87, v106
  v_perm_b32 v205, v87, v87, v107
  v_mfma_f32_16x16x16_bf16 v[32:35], v[172:173], v[200:201], v[32:35]
  v_perm_b32 v206, v87, v87, v108
  v_perm_b32 v207, v87, v87, v109
  v_mfma_f32_16x16x16_bf16 v[32:35], v[174:175], v[202:203], v[32:35]
  v_perm_b32 v200, v88, v88, v106
  v_perm_b32 v201, v88, v88, v107
  v_mfma_f32_16x16x16_bf16 v[32:35], v[176:177], v[204:205], v[32:35]
  v_perm_b32 v202, v88, v88, v108
  v_perm_b32 v203, v88, v88, v109
  v_mfma_f32_16x16x16_bf16 v[32:35], v[178:179], v[206:207], v[32:35]
  v_perm_b32 v204, v89, v89, v106
  v_perm_b32 v205, v89, v89, v107
  v_mfma_f32_16x16x16_bf16 v[32:35], v[180:181], v[200:201], v[32:35]
  v_perm_b32 v206, v89, v89, v108
  v_perm_b32 v207, v89, v89, v109
  v_mfma_f32_16x16x16_bf16 v[32:35], v[182:183], v[202:203], v[32:35]
  v_perm_b32 v200, v90, v90, v106
  v_perm_b32 v201, v90, v90, v107
  v_mfma_f32_16x16x16_bf16 v[32:35], v[184:185], v[204:205], v[32:35]
  v_perm_b32 v202, v90, v90, v108
  v_perm_b32 v203, v90, v90, v109
  v_mfma_f32_16x16x16_bf16 v[32:35], v[186:187], v[206:207], v[32:35]
  v_perm_b32 v204, v91, v91, v106
  v_perm_b32 v205, v91, v91, v107
  v_mfma_f32_16x16x16_bf16 v[32:35], v[188:189], v[200:201], v[32:35]
  v_perm_b32 v206, v91, v91, v108
  v_perm_b32 v207, v91, v91, v109
  v_mfma_f32_16x16x16_bf16 v[32:35], v[190:191], v[202:203], v[32:35]
  v_perm_b32 v200, v92, v92, v106
  v_perm_b32 v201, v92, v92, v107
  v_mfma_f32_16x16x16_bf16 v[32:35], v[192:193], v[204:205], v[32:35]
  v_perm_b32 v202, v92, v92, v108
  v_perm_b32 v203, v92, v92, v109
  v_mfma_f32_16x16x16_bf16 v[32:35], v[194:195], v[206:207], v[32:35]
  v_mfma_f32_16x16x16_bf16 v[32:35], v[196:197], v[200:201], v[32:35]
  v_mfma_f32_16x16x16_bf16 v[32:35], v[198:199], v[202:203], v[32:35]
  s_lshl_b32 s62, s34, 8
  s_add_u32 s62, s62, 147456
  v_lshlrev_b32 v26, 2, v1
  v_add_u32 v26, s62, v26
  v_bfe_u32 v25, v1, 2, 2
  v_cmp_eq_u32 vcc, 1, v25
  v_cmp_eq_u32 s[96:97], 2, v25
  v_cmp_eq_u32 s[94:95], 3, v25
  v_cndmask_b32 v27, v32, v33, vcc
  v_cndmask_b32 v27, v27, v34, s[96:97]
  v_cndmask_b32 v27, v27, v35, s[94:95]
  ds_write_b32 v26, v27
  s_waitcnt lgkmcnt(0)
  s_barrier
  s_cmp_eq_u32 s34, 4
  s_cbranch_scc0 L_noh
  v_lshlrev_b32 v24, 2, v1
  v_add_u32 v24, 147456, v24
  ds_read_b32 v25, v24 offset:0
  ds_read_b32 v26, v24 offset:256
  ds_read_b32 v27, v24 offset:512
  ds_read_b32 v28, v24 offset:768
  ds_read_b32 v29, v24 offset:1024
  ds_read_b32 v30, v24 offset:1280
  ds_read_b32 v31, v24 offset:1536
  ds_read_b32 v32, v24 offset:1792
  s_waitcnt lgkmcnt(0)
  v_add_f32 v25, v25, v26
  v_add_f32 v25, v25, v27
  v_add_f32 v25, v25, v28
  v_add_f32 v25, v25, v29
  v_add_f32 v25, v25, v30
  v_add_f32 v25, v25, v31
  v_add_f32 v25, v25, v32
  v_cvt_pk_bf16_f32 v25, 0, v25
  v_lshlrev_b32 v26, 16, v126
  v_add_f32 v25, v25, v26
  v_cvt_pk_bf16_f32 v25, 0, v25
  v_max_f32 v25, 0, v25
  v_mul_f32 v24, v25, v25
  v_cvt_pk_bf16_f32 v24, 0, v24
  v_mov_b32 v25, s35
  s_mul_i32 s62, s33, 288
  s_mul_i32 s63, s32, 36
  s_add_u32 s62, s62, s63
  s_lshl_b32 s62, s62, 3
  s_add_u32 s62, s62, 4096
  v_lshlrev_b32 v26, 3, v1
  v_cmp_gt_u32 vcc, 36, v1
  s_nop 0
  s_and_saveexec_b64 s[94:95], vcc
  buffer_store_dwordx2 v[24:25], v26, s[44:47], s62 offen sc1
  s_mov_b64 exec, s[94:95]
L_noh:
  s_mov_b32 s61, 34
  s_lshl_b32 s80, s76, 7
  s_add_u32 s80, s80, 98304
  v_mov_b32 v130, 0
.p2align 6
L_loop:
  s_waitcnt vmcnt(2)
  v_mfma_f32_16x16x32_bf16 v[24:27], v[48:51], v[4:7], 0
  v_mfma_f32_16x16x32_bf16 v[28:31], v[52:55], v[4:7], 0
  buffer_load_dwordx4 v[48:51], v2, s[36:39], s60 offen offset:0 nt
  buffer_load_dwordx4 v[52:55], v2, s[36:39], s60 offen offset:1024 nt
  s_nop 4
  v_mov_b32_dpp v40, v24 quad_perm:[0,0,0,0] row_mask:0xf bank_mask:0xf
  v_mov_b32_dpp v41, v28 quad_perm:[0,0,0,0] row_mask:0xf bank_mask:0xf
  v_mov_b32_dpp v44, v26 quad_perm:[2,2,2,2] row_mask:0xf bank_mask:0xf
  v_mov_b32_dpp v45, v30 quad_perm:[2,2,2,2] row_mask:0xf bank_mask:0xf
  v_add_f32_dpp v40, v25, v40 quad_perm:[1,1,1,1] row_mask:0xf bank_mask:0xf
  v_add_f32_dpp v41, v29, v41 quad_perm:[1,1,1,1] row_mask:0xf bank_mask:0xf
  v_add_f32_dpp v44, v27, v44 quad_perm:[3,3,3,3] row_mask:0xf bank_mask:0xf
  v_add_f32_dpp v45, v31, v45 quad_perm:[3,3,3,3] row_mask:0xf bank_mask:0xf
  v_add_f32 v40, v40, v44
  v_add_f32 v41, v41, v45
  v_cvt_pk_bf16_f32 v40, 0, v40
  v_cvt_pk_bf16_f32 v41, 0, v41
  v_mul_f32 v40, s92, v40
  v_mul_f32 v41, s92, v41
  v_cvt_pk_bf16_f32 v40, 0, v40
  v_cvt_pk_bf16_f32 v41, 0, v41
  v_max3_f32 v15, v12, v40, v41
  v_mov_b32 v16, v15
  s_nop 1
  v_permlane16_swap_b32 v15, v16
  s_nop 0
  v_max_f32 v15, v15, v16
  v_mov_b32 v16, v15
  s_nop 1
  v_permlane32_swap_b32 v15, v16
  s_nop 0
  v_max_f32 v15, v15, v16
  v_mul_f32 v16, s91, v15
  v_mov_b32 v12, v15
  v_sub_f32 v17, v14, v16
  v_fma_f32 v40, v40, s91, -v16
  v_fma_f32 v41, v41, s91, -v16
  v_exp_f32 v17, v17
  v_exp_f32 v40, v40
  v_exp_f32 v41, v41
  v_mov_b32 v14, v16
  v_fma_f32 v13, v13, v17, v40
  v_mul_f32 v20, v20, v17
  v_mul_f32 v21, v21, v17
  v_mul_f32 v22, v22, v17
  v_mul_f32 v23, v23, v17
  v_add_f32 v13, v13, v41
  v_cvt_pk_bf16_f32 v40, v40, v40
  v_cvt_pk_bf16_f32 v41, v41, v41
  v_and_b32 v24, v40, v8
  v_and_b32 v25, v40, v9
  v_and_b32 v26, v40, v10
  v_and_b32 v27, v40, v11
  v_and_b32 v28, v41, v8
  v_and_b32 v29, v41, v9
  v_and_b32 v30, v41, v10
  v_and_b32 v31, v41, v11
  s_waitcnt vmcnt(2)
  v_mfma_f32_16x16x32_bf16 v[20:23], v[56:59], v[24:27], v[20:23]
  v_mfma_f32_16x16x32_bf16 v[20:23], v[60:63], v[28:31], v[20:23]
  buffer_load_dwordx4 v[56:59], v3, s[40:43], s60 offen offset:0 nt
  buffer_load_dwordx4 v[60:63], v3, s[40:43], s60 offen offset:1024 nt
  s_add_u32 s60, s60, 16384
  s_sub_u32 s61, s61, 1
  s_cmp_lg_u32 s61, 0
  s_cbranch_scc1 L_loop
  v_bfe_u32 v24, v1, 3, 1
  v_lshlrev_b32 v236, 9, v24
  v_lshrrev_b32 v25, 4, v1
  v_lshl_add_u32 v236, v25, 7, v236
  v_and_b32 v26, 7, v1
  v_lshl_add_u32 v236, v26, 2, v236
  s_lshl_b32 s62, s34, 10
  s_add_u32 s62, s62, 139264
  v_add_u32 v236, s62, v236
  v_lshlrev_b32 v237, 3, v24
  s_lshl_b32 s62, s34, 4
  s_add_u32 s62, s62, 150016
  v_add_u32 v237, s62, v237
  v_lshlrev_b32 v243, 7, v25
  v_lshl_add_u32 v243, v24, 6, v243
  v_lshl_add_u32 v243, v26, 2, v243
  s_lshl_b32 s62, s34, 9
  s_add_u32 s62, s62, 151296
  v_add_u32 v243, s62, v243
  s_cmp_lt_u32 s34, 4
  s_cselect_b32 s62, 16, 18
  v_mul_u32_u24 v27, s62, v25
  v_mul_u32_u24 v28, 9, v27
  v_and_b32 v29, 15, v1
  v_min_u32 v29, 8, v29
  v_add_u32 v28, v28, v29
  v_lshlrev_b32 v28, 4, v28
  s_mul_i32 s64, s34, 11264
  s_add_u32 s64, s64, 49152
  v_add_u32 v28, s64, v28
  v_lshlrev_b32 v238, 2, v0
  v_add_u32 v238, 139264, v238
  v_lshlrev_b32 v239, 3, v0
  v_lshlrev_b32 v240, 5, v26
  v_lshl_add_u32 v240, v24, 4, v240
  v_lshlrev_b32 v241, 1, v0
  v_add_u32 v241, 150144, v241
  v_lshlrev_b32 v242, 5, v25
  s_lshl_b32 s63, s34, 7
  s_add_u32 s63, s63, 150144
  v_add_u32 v242, s63, v242
  v_min_u32 v30, 71, v0
  v_lshlrev_b32 v244, 2, v30
  v_add_u32 v244, 151296, v244
  v_lshlrev_b32 v245, 4, v30
  v_min_u32 v30, 143, v0
  v_lshlrev_b32 v246, 3, v30
  v_lshrrev_b32 v30, 1, v30
  v_lshlrev_b32 v249, 1, v30
  s_cmp_lt_u32 s34, 4
  s_cbranch_scc0 L_pt_b
  ds_read_b128 v[164:167], v28 offset:0
  ds_read_b128 v[168:171], v28 offset:144
  ds_read_b128 v[172:175], v28 offset:288
  ds_read_b128 v[176:179], v28 offset:432
  ds_read_b128 v[180:183], v28 offset:576
  ds_read_b128 v[184:187], v28 offset:720
  ds_read_b128 v[188:191], v28 offset:864
  ds_read_b128 v[192:195], v28 offset:1008
  ds_read_b128 v[196:199], v28 offset:1152
  ds_read_b128 v[200:203], v28 offset:1296
  ds_read_b128 v[204:207], v28 offset:1440
  ds_read_b128 v[208:211], v28 offset:1584
  ds_read_b128 v[212:215], v28 offset:1728
  ds_read_b128 v[216:219], v28 offset:1872
  ds_read_b128 v[220:223], v28 offset:2016
  ds_read_b128 v[224:227], v28 offset:2160
  s_mul_i32 s62, s30, 1152
  s_mul_i32 s63, s32, 144
  s_add_u32 s62, s62, s63
  s_mov_b32 s48, s8
  s_and_b32 s49, s9, 0xffff
  s_mov_b32 s50, 2304
  s_mov_b32 s51, 0x20000
  s_mov_b32 s52, s26
  s_and_b32 s53, s27, 0xffff
  s_mov_b32 s54, 1152
  s_mov_b32 s55, 0x20000
  buffer_load_ushort v247, v249, s[48:51], s62 offen nt
  buffer_load_ushort v248, v249, s[52:55], s63 offen nt
  s_mov_b32 s48, s18
  s_and_b32 s49, s19, 0xffff
  s_mov_b32 s50, 2304
  s_mov_b32 s51, 0x20000
  s_waitcnt lgkmcnt(0)
  s_branch L_pt_done
L_pt_b:
  s_mul_i32 s62, s33, 288
  s_mul_i32 s63, s34, 72
  s_add_u32 s62, s62, s63
  s_sub_u32 s62, s62, 288
  s_lshl_b32 s62, s62, 3
  s_add_u32 s62, s62, 4096
  v_lshlrev_b32 v30, 3, v1
  v_and_b32 v31, 7, v1
  v_lshlrev_b32 v31, 3, v31
  ds_read_b128 v[164:167], v28 offset:0
  ds_read_b128 v[168:171], v28 offset:144
  ds_read_b128 v[172:175], v28 offset:288
  ds_read_b128 v[176:179], v28 offset:432
  ds_read_b128 v[180:183], v28 offset:576
  ds_read_b128 v[184:187], v28 offset:720
  ds_read_b128 v[188:191], v28 offset:864
  ds_read_b128 v[192:195], v28 offset:1008
  ds_read_b128 v[196:199], v28 offset:1152
  ds_read_b128 v[200:203], v28 offset:1296
  ds_read_b128 v[204:207], v28 offset:1440
  ds_read_b128 v[208:211], v28 offset:1584
  ds_read_b128 v[212:215], v28 offset:1728
  ds_read_b128 v[216:219], v28 offset:1872
  ds_read_b128 v[220:223], v28 offset:2016
  ds_read_b128 v[224:227], v28 offset:2160
  ds_read_b128 v[228:231], v28 offset:2304
  ds_read_b128 v[232:235], v28 offset:2448
L_gather_h:
  buffer_load_dwordx2 v[32:33], v30, s[44:47], s62 offen sc1
  buffer_load_dwordx2 v[34:35], v31, s[44:47], s62 offen offset:512 sc1
  s_waitcnt vmcnt(0)
  v_xor_b32 v36, s35, v33
  v_xor_b32 v37, s35, v35
  v_or_b32 v36, v36, v37
  v_cmp_ne_u32 vcc, 0, v36
  s_cbranch_vccz L_h_ok
  s_sub_u32 s90, s90, 1
  s_cmp_eq_u32 s90, 0
  s_cbranch_scc1 L_h_ok
  s_sleep 1
  s_branch L_gather_h
L_h_ok:
  s_mul_i32 s63, s34, 144
  s_add_u32 s63, s63, 150080
  v_lshlrev_b32 v36, 1, v1
  v_add_u32 v36, s63, v36
  ds_write_b16_d16_hi v36, v32
  v_and_b32 v37, 7, v1
  v_lshlrev_b32 v37, 1, v37
  v_add_u32 v37, s63, v37
  ds_write_b16_d16_hi v37, v34 offset:128
  v_lshlrev_b32 v27, 1, v27
  v_add_u32 v27, s63, v27
  s_waitcnt lgkmcnt(0)
  ds_read_b32 v32, v27 offset:0
  ds_read_b32 v33, v27 offset:4
  ds_read_b32 v34, v27 offset:8
  ds_read_b32 v35, v27 offset:12
  ds_read_b32 v36, v27 offset:16
  ds_read_b32 v37, v27 offset:20
  ds_read_b32 v38, v27 offset:24
  ds_read_b32 v39, v27 offset:28
  ds_read_b32 v40, v27 offset:32
  s_waitcnt lgkmcnt(0)
  v_perm_b32 v110, v32, v32, v94
  v_perm_b32 v111, v32, v32, v95
  v_perm_b32 v112, v32, v32, v96
  v_perm_b32 v113, v32, v32, v97
  v_perm_b32 v114, v32, v32, v98
  v_perm_b32 v115, v32, v32, v99
  v_perm_b32 v116, v32, v32, v100
  v_perm_b32 v117, v32, v32, v101
  v_perm_b32 v118, v33, v33, v94
  v_perm_b32 v119, v33, v33, v95
  v_perm_b32 v120, v33, v33, v96
  v_perm_b32 v121, v33, v33, v97
  v_mfma_f32_16x16x32_bf16 v[24:27], v[164:167], v[110:113], 0
  v_perm_b32 v122, v33, v33, v98
  v_perm_b32 v123, v33, v33, v99
  v_perm_b32 v124, v33, v33, v100
  v_perm_b32 v125, v33, v33, v101
  v_mfma_f32_16x16x32_bf16 v[24:27], v[168:171], v[114:117], v[24:27]
  v_perm_b32 v110, v34, v34, v94
  v_perm_b32 v111, v34, v34, v95
  v_perm_b32 v112, v34, v34, v96
  v_perm_b32 v113, v34, v34, v97
  v_mfma_f32_16x16x32_bf16 v[24:27], v[172:175], v[118:121], v[24:27]
  v_perm_b32 v114, v34, v34, v98
  v_perm_b32 v115, v34, v34, v99
  v_perm_b32 v116, v34, v34, v100
  v_perm_b32 v117, v34, v34, v101
  v_mfma_f32_16x16x32_bf16 v[24:27], v[176:179], v[122:125], v[24:27]
  v_perm_b32 v118, v35, v35, v94
  v_perm_b32 v119, v35, v35, v95
  v_perm_b32 v120, v35, v35, v96
  v_perm_b32 v121, v35, v35, v97
  v_mfma_f32_16x16x32_bf16 v[24:27], v[180:183], v[110:113], v[24:27]
  v_perm_b32 v122, v35, v35, v98
  v_perm_b32 v123, v35, v35, v99
  v_perm_b32 v124, v35, v35, v100
  v_perm_b32 v125, v35, v35, v101
  v_mfma_f32_16x16x32_bf16 v[24:27], v[184:187], v[114:117], v[24:27]
  v_perm_b32 v110, v36, v36, v94
  v_perm_b32 v111, v36, v36, v95
  v_perm_b32 v112, v36, v36, v96
  v_perm_b32 v113, v36, v36, v97
  v_mfma_f32_16x16x32_bf16 v[24:27], v[188:191], v[118:121], v[24:27]
  v_perm_b32 v114, v36, v36, v98
  v_perm_b32 v115, v36, v36, v99
  v_perm_b32 v116, v36, v36, v100
  v_perm_b32 v117, v36, v36, v101
  v_mfma_f32_16x16x32_bf16 v[24:27], v[192:195], v[122:125], v[24:27]
  v_perm_b32 v118, v37, v37, v94
  v_perm_b32 v119, v37, v37, v95
  v_perm_b32 v120, v37, v37, v96
  v_perm_b32 v121, v37, v37, v97
  v_mfma_f32_16x16x32_bf16 v[24:27], v[196:199], v[110:113], v[24:27]
  v_perm_b32 v122, v37, v37, v98
  v_perm_b32 v123, v37, v37, v99
  v_perm_b32 v124, v37, v37, v100
  v_perm_b32 v125, v37, v37, v101
  v_mfma_f32_16x16x32_bf16 v[24:27], v[200:203], v[114:117], v[24:27]
  v_perm_b32 v110, v38, v38, v94
  v_perm_b32 v111, v38, v38, v95
  v_perm_b32 v112, v38, v38, v96
  v_perm_b32 v113, v38, v38, v97
  v_mfma_f32_16x16x32_bf16 v[24:27], v[204:207], v[118:121], v[24:27]
  v_perm_b32 v114, v38, v38, v98
  v_perm_b32 v115, v38, v38, v99
  v_perm_b32 v116, v38, v38, v100
  v_perm_b32 v117, v38, v38, v101
  v_mfma_f32_16x16x32_bf16 v[24:27], v[208:211], v[122:125], v[24:27]
  v_perm_b32 v118, v39, v39, v94
  v_perm_b32 v119, v39, v39, v95
  v_perm_b32 v120, v39, v39, v96
  v_perm_b32 v121, v39, v39, v97
  v_mfma_f32_16x16x32_bf16 v[24:27], v[212:215], v[110:113], v[24:27]
  v_perm_b32 v122, v39, v39, v98
  v_perm_b32 v123, v39, v39, v99
  v_perm_b32 v124, v39, v39, v100
  v_perm_b32 v125, v39, v39, v101
  v_mfma_f32_16x16x32_bf16 v[24:27], v[216:219], v[114:117], v[24:27]
  v_perm_b32 v110, v40, v40, v94
  v_perm_b32 v111, v40, v40, v95
  v_perm_b32 v112, v40, v40, v96
  v_perm_b32 v113, v40, v40, v97
  v_mfma_f32_16x16x32_bf16 v[24:27], v[220:223], v[118:121], v[24:27]
  v_perm_b32 v114, v40, v40, v98
  v_perm_b32 v115, v40, v40, v99
  v_perm_b32 v116, v40, v40, v100
  v_perm_b32 v117, v40, v40, v101
  v_mfma_f32_16x16x32_bf16 v[24:27], v[224:227], v[122:125], v[24:27]
  v_mfma_f32_16x16x32_bf16 v[24:27], v[228:231], v[110:113], v[24:27]
  v_mfma_f32_16x16x32_bf16 v[24:27], v[232:235], v[114:117], v[24:27]
  s_nop 7
  v_cndmask_b32 v28, v24, v26, s[74:75]
  v_cndmask_b32 v29, v25, v27, s[74:75]
  ds_write_b32 v243, v28
  ds_write_b32 v243, v29 offset:32
  s_waitcnt lgkmcnt(0)
L_pt_done:
  s_waitcnt vmcnt(2)
  v_mfma_f32_16x16x32_bf16 v[24:27], v[48:51], v[4:7], 0
  v_mfma_f32_16x16x32_bf16 v[28:31], v[52:55], v[4:7], 0
  buffer_load_dwordx4 v[48:51], v2, s[36:39], s60 offen offset:0 nt
  buffer_load_dwordx4 v[52:55], v2, s[36:39], s60 offen offset:1024 nt
  v_mov_b32 v128, 1
  v_mov_b32 v129, 0
  v_mov_b32 v130, 0
  s_mov_b64 exec, 1
  buffer_atomic_add_x2 v[128:129], v130, s[44:47], s80 offen sc0
  s_mov_b64 exec, -1
  v_mov_b32_dpp v40, v24 quad_perm:[0,0,0,0] row_mask:0xf bank_mask:0xf
  v_mov_b32_dpp v41, v28 quad_perm:[0,0,0,0] row_mask:0xf bank_mask:0xf
  v_mov_b32_dpp v44, v26 quad_perm:[2,2,2,2] row_mask:0xf bank_mask:0xf
  v_mov_b32_dpp v45, v30 quad_perm:[2,2,2,2] row_mask:0xf bank_mask:0xf
  v_add_f32_dpp v40, v25, v40 quad_perm:[1,1,1,1] row_mask:0xf bank_mask:0xf
  v_add_f32_dpp v41, v29, v41 quad_perm:[1,1,1,1] row_mask:0xf bank_mask:0xf
  v_add_f32_dpp v44, v27, v44 quad_perm:[3,3,3,3] row_mask:0xf bank_mask:0xf
  v_add_f32_dpp v45, v31, v45 quad_perm:[3,3,3,3] row_mask:0xf bank_mask:0xf
  v_add_f32 v40, v40, v44
  v_add_f32 v41, v41, v45
  v_cvt_pk_bf16_f32 v40, 0, v40
  v_cvt_pk_bf16_f32 v41, 0, v41
  v_mul_f32 v40, s92, v40
  v_mul_f32 v41, s92, v41
  v_cvt_pk_bf16_f32 v40, 0, v40
  v_cvt_pk_bf16_f32 v41, 0, v41
  v_max3_f32 v15, v12, v40, v41
  v_mov_b32 v16, v15
  s_nop 1
  v_permlane16_swap_b32 v15, v16
  s_nop 0
  v_max_f32 v15, v15, v16
  v_mov_b32 v16, v15
  s_nop 1
  v_permlane32_swap_b32 v15, v16
  s_nop 0
  v_max_f32 v15, v15, v16
  v_mul_f32 v16, s91, v15
  v_mov_b32 v12, v15
  v_sub_f32 v17, v14, v16
  v_fma_f32 v40, v40, s91, -v16
  v_fma_f32 v41, v41, s91, -v16
  v_exp_f32 v17, v17
  v_exp_f32 v40, v40
  v_exp_f32 v41, v41
  v_mov_b32 v14, v16
  v_fma_f32 v13, v13, v17, v40
  v_mul_f32 v20, v20, v17
  v_mul_f32 v21, v21, v17
  v_mul_f32 v22, v22, v17
  v_mul_f32 v23, v23, v17
  v_add_f32 v13, v13, v41
  v_cvt_pk_bf16_f32 v40, v40, v40
  v_cvt_pk_bf16_f32 v41, v41, v41
  v_and_b32 v24, v40, v8
  v_and_b32 v25, v40, v9
  v_and_b32 v26, v40, v10
  v_and_b32 v27, v40, v11
  v_and_b32 v28, v41, v8
  v_and_b32 v29, v41, v9
  v_and_b32 v30, v41, v10
  v_and_b32 v31, v41, v11
  s_waitcnt vmcnt(3)
  v_mfma_f32_16x16x32_bf16 v[20:23], v[56:59], v[24:27], v[20:23]
  v_mfma_f32_16x16x32_bf16 v[20:23], v[60:63], v[28:31], v[20:23]
  buffer_load_dwordx4 v[56:59], v3, s[40:43], s60 offen offset:0 nt
  buffer_load_dwordx4 v[60:63], v3, s[40:43], s60 offen offset:1024 nt
  s_add_u32 s60, s60, 16384
.p2align 6
L_loopD:
  s_waitcnt vmcnt(2)
  v_mfma_f32_16x16x32_bf16 v[24:27], v[48:51], v[4:7], 0
  v_mfma_f32_16x16x32_bf16 v[28:31], v[52:55], v[4:7], 0
  v_readfirstlane_b32 s62, v128
  v_readfirstlane_b32 s63, v129
  s_nop 0
  s_cmp_lg_u32 s63, s35
  s_cbranch_scc1 L_ctr_retry
L_ctr_ok:
  s_lshr_b32 s63, s62, 6
  s_and_b32 s64, s62, 63
  s_lshl_b32 s63, s63, 20
  s_add_u32 s64, s64, 448
  s_mul_i32 s64, s64, 2048
  s_add_u32 s79, s63, s64
  s_cmp_ge_u32 s62, 512
  s_cselect_b32 s79, 8388608, s79
  s_cbranch_scc1 L_dskipk
  buffer_load_dwordx4 v[48:51], v2, s[36:39], s79 offen offset:0 nt
  buffer_load_dwordx4 v[52:55], v2, s[36:39], s79 offen offset:1024 nt
  v_mov_b32 v128, 1
  v_mov_b32 v129, 0
  v_mov_b32 v130, 0
  s_mov_b64 exec, 1
  buffer_atomic_add_x2 v[128:129], v130, s[44:47], s80 offen sc0
  s_mov_b64 exec, -1
L_dskipk:
  v_mov_b32_dpp v40, v24 quad_perm:[0,0,0,0] row_mask:0xf bank_mask:0xf
  v_mov_b32_dpp v41, v28 quad_perm:[0,0,0,0] row_mask:0xf bank_mask:0xf
  v_mov_b32_dpp v44, v26 quad_perm:[2,2,2,2] row_mask:0xf bank_mask:0xf
  v_mov_b32_dpp v45, v30 quad_perm:[2,2,2,2] row_mask:0xf bank_mask:0xf
  v_add_f32_dpp v40, v25, v40 quad_perm:[1,1,1,1] row_mask:0xf bank_mask:0xf
  v_add_f32_dpp v41, v29, v41 quad_perm:[1,1,1,1] row_mask:0xf bank_mask:0xf
  v_add_f32_dpp v44, v27, v44 quad_perm:[3,3,3,3] row_mask:0xf bank_mask:0xf
  v_add_f32_dpp v45, v31, v45 quad_perm:[3,3,3,3] row_mask:0xf bank_mask:0xf
  v_add_f32 v40, v40, v44
  v_add_f32 v41, v41, v45
  v_cvt_pk_bf16_f32 v40, 0, v40
  v_cvt_pk_bf16_f32 v41, 0, v41
  v_mul_f32 v40, s92, v40
  v_mul_f32 v41, s92, v41
  v_cvt_pk_bf16_f32 v40, 0, v40
  v_cvt_pk_bf16_f32 v41, 0, v41
  v_max3_f32 v15, v12, v40, v41
  v_mov_b32 v16, v15
  s_nop 1
  v_permlane16_swap_b32 v15, v16
  s_nop 0
  v_max_f32 v15, v15, v16
  v_mov_b32 v16, v15
  s_nop 1
  v_permlane32_swap_b32 v15, v16
  s_nop 0
  v_max_f32 v15, v15, v16
  v_mul_f32 v16, s91, v15
  v_mov_b32 v12, v15
  v_sub_f32 v17, v14, v16
  v_fma_f32 v40, v40, s91, -v16
  v_fma_f32 v41, v41, s91, -v16
  v_exp_f32 v17, v17
  v_exp_f32 v40, v40
  v_exp_f32 v41, v41
  v_mov_b32 v14, v16
  v_fma_f32 v13, v13, v17, v40
  v_mul_f32 v20, v20, v17
  v_mul_f32 v21, v21, v17
  v_mul_f32 v22, v22, v17
  v_mul_f32 v23, v23, v17
  v_add_f32 v13, v13, v41
  v_cvt_pk_bf16_f32 v40, v40, v40
  v_cvt_pk_bf16_f32 v41, v41, v41
  v_and_b32 v24, v40, v8
  v_and_b32 v25, v40, v9
  v_and_b32 v26, v40, v10
  v_and_b32 v27, v40, v11
  v_and_b32 v28, v41, v8
  v_and_b32 v29, v41, v9
  v_and_b32 v30, v41, v10
  v_and_b32 v31, v41, v11
  s_cmp_ge_u32 s79, 8388608
  s_cbranch_scc1 L_dlast
  s_waitcnt vmcnt(3)
  v_mfma_f32_16x16x32_bf16 v[20:23], v[56:59], v[24:27], v[20:23]
  v_mfma_f32_16x16x32_bf16 v[20:23], v[60:63], v[28:31], v[20:23]
  buffer_load_dwordx4 v[56:59], v3, s[40:43], s79 offen offset:0 nt
  buffer_load_dwordx4 v[60:63], v3, s[40:43], s79 offen offset:1024 nt
  s_branch L_loopD
L_dlast:
  s_waitcnt vmcnt(0)
  v_mfma_f32_16x16x32_bf16 v[20:23], v[56:59], v[24:27], v[20:23]
  v_mfma_f32_16x16x32_bf16 v[20:23], v[60:63], v[28:31], v[20:23]
  s_branch L_stream_done
L_ctr_retry:
  s_waitcnt vmcnt(0)
  s_sub_u32 s90, s90, 1
  s_cmp_eq_u32 s90, 0
  s_cbranch_scc1 L_ctr_giveup
  s_sleep 1
  v_mov_b32 v128, 1
  v_mov_b32 v129, 0
  v_mov_b32 v130, 0
  s_mov_b64 exec, 1
  buffer_atomic_add_x2 v[128:129], v130, s[44:47], s80 offen sc0
  s_mov_b64 exec, -1
  s_waitcnt vmcnt(0)
  v_readfirstlane_b32 s62, v128
  v_readfirstlane_b32 s63, v129
  s_nop 0
  s_cmp_lg_u32 s63, s35
  s_cbranch_scc1 L_ctr_retry
  s_branch L_ctr_ok
L_ctr_giveup:
  s_mov_b32 s62, 512
  s_branch L_ctr_ok
L_stream_done:
  s_waitcnt vmcnt(0)
  v_mov_b32 v15, v13
  s_nop 1
  v_permlane16_swap_b32 v13, v15
  s_nop 0
  v_add_f32 v13, v13, v15
  v_mov_b32 v15, v13
  s_nop 1
  v_permlane32_swap_b32 v13, v15
  s_nop 0
  v_add_f32 v13, v13, v15
  ds_write_b32 v236, v20 offset:0
  ds_write_b32 v236, v21 offset:32
  ds_write_b32 v236, v22 offset:64
  ds_write_b32 v236, v23 offset:96
  v_mov_b32 v26, v12
  v_mov_b32 v27, v13
  s_mov_b64 exec, 0x101
  ds_write_b64 v237, v[26:27]
  s_mov_b64 exec, -1
  s_waitcnt lgkmcnt(0)
  s_barrier
  s_cmp_lt_u32 s34, 4
  s_cbranch_scc0 L_bpub
  s_lshr_b32 s62, s34, 1
  s_lshl_b32 s63, s62, 3
  s_add_u32 s63, s63, 150016
  v_mov_b32 v24, s63
  ds_read_b64 v[28:29], v24 offset:0
  ds_read_b64 v[30:31], v24 offset:16
  ds_read_b64 v[32:33], v24 offset:32
  ds_read_b64 v[34:35], v24 offset:48
  ds_read_b64 v[36:37], v24 offset:64
  ds_read_b64 v[38:39], v24 offset:80
  ds_read_b64 v[40:41], v24 offset:96
  ds_read_b64 v[42:43], v24 offset:112
  ds_read_b32 v44, v238 offset:0
  ds_read_b32 v45, v238 offset:1024
  ds_read_b32 v46, v238 offset:2048
  ds_read_b32 v47, v238 offset:3072
  ds_read_b32 v48, v238 offset:4096
  ds_read_b32 v49, v238 offset:5120
  ds_read_b32 v50, v238 offset:6144
  ds_read_b32 v51, v238 offset:7168
  s_lshl_b32 s63, s76, 3
  s_or_b32 s63, s63, s77
  s_lshl_b32 s64, s63, 11
  s_add_u32 s64, s64, 131072
  v_mov_b32 v53, s35
  s_waitcnt lgkmcnt(8)
  v_max3_f32 v26, v28, v30, v32
  v_max3_f32 v26, v26, v34, v36
  v_max3_f32 v26, v26, v38, v40
  v_max_f32 v26, v26, v42
  v_sub_f32 v28, v28, v26
  v_sub_f32 v30, v30, v26
  v_sub_f32 v32, v32, v26
  v_sub_f32 v34, v34, v26
  v_sub_f32 v36, v36, v26
  v_sub_f32 v38, v38, v26
  v_sub_f32 v40, v40, v26
  v_sub_f32 v42, v42, v26
  v_mul_f32 v28, s91, v28
  v_mul_f32 v30, s91, v30
  v_mul_f32 v32, s91, v32
  v_mul_f32 v34, s91, v34
  v_mul_f32 v36, s91, v36
  v_mul_f32 v38, s91, v38
  v_mul_f32 v40, s91, v40
  v_mul_f32 v42, s91, v42
  v_exp_f32 v28, v28
  v_exp_f32 v30, v30
  v_exp_f32 v32, v32
  v_exp_f32 v34, v34
  v_exp_f32 v36, v36
  v_exp_f32 v38, v38
  v_exp_f32 v40, v40
  v_exp_f32 v42, v42
  s_waitcnt lgkmcnt(0)
  v_mul_f32 v52, v28, v44
  v_mul_f32 v27, v28, v29
  v_fmac_f32 v52, v30, v45
  v_fmac_f32 v27, v30, v31
  v_fmac_f32 v52, v32, v46
  v_fmac_f32 v27, v32, v33
  v_fmac_f32 v52, v34, v47
  v_fmac_f32 v27, v34, v35
  v_fmac_f32 v52, v36, v48
  v_fmac_f32 v27, v36, v37
  v_fmac_f32 v52, v38, v49
  v_fmac_f32 v27, v38, v39
  v_fmac_f32 v52, v40, v50
  v_fmac_f32 v27, v40, v41
  v_fmac_f32 v52, v42, v51
  v_fmac_f32 v27, v42, v43
  buffer_store_dwordx2 v[52:53], v239, s[44:47], s64 offen sc1
  s_and_b32 s64, s34, 1
  s_cmp_eq_u32 s64, 0
  s_cbranch_scc0 L_ml_done
  v_cmp_eq_u32 vcc, 1, v1
  s_lshl_b32 s64, s63, 5
  s_lshl_b32 s65, s62, 3
  s_add_u32 s64, s64, s65
  s_add_u32 s64, s64, 81920
  v_cndmask_b32 v56, v26, v27, vcc
  v_mov_b32 v57, s35
  v_lshlrev_b32 v58, 4, v1
  s_mov_b64 exec, 3
  buffer_store_dwordx2 v[56:57], v58, s[44:47], s64 offen sc1
  s_mov_b64 exec, -1
L_ml_done:
  s_lshl_b32 s64, s33, 8
  s_lshl_b32 s65, s62, 3
  s_add_u32 s64, s64, s65
  s_add_u32 s64, s64, 81920
  s_lshl_b32 s65, s33, 14
  s_add_u32 s65, s65, 131072
L_poll_ml:
  buffer_load_dwordx2 v[26:27], v240, s[44:47], s64 offen sc1
  s_waitcnt vmcnt(0)
  v_cmp_ne_u32 vcc, s35, v27
  s_cbranch_vccz L_ml_ok
  s_sub_u32 s90, s90, 1
  s_cmp_eq_u32 s90, 0
  s_cbranch_scc1 L_ml_ok
  s_sleep 1
  s_branch L_poll_ml
L_ml_ok:
L_gather_o:
  s_mov_b32 s64, s65
  buffer_load_dwordx2 v[28:29], v239, s[44:47], s64 offen sc1
  s_add_u32 s64, s64, 2048
  buffer_load_dwordx2 v[30:31], v239, s[44:47], s64 offen sc1
  s_add_u32 s64, s64, 2048
  buffer_load_dwordx2 v[32:33], v239, s[44:47], s64 offen sc1
  s_add_u32 s64, s64, 2048
  buffer_load_dwordx2 v[34:35], v239, s[44:47], s64 offen sc1
  s_add_u32 s64, s64, 2048
  buffer_load_dwordx2 v[36:37], v239, s[44:47], s64 offen sc1
  s_add_u32 s64, s64, 2048
  buffer_load_dwordx2 v[38:39], v239, s[44:47], s64 offen sc1
  s_add_u32 s64, s64, 2048
  buffer_load_dwordx2 v[40:41], v239, s[44:47], s64 offen sc1
  s_add_u32 s64, s64, 2048
  buffer_load_dwordx2 v[42:43], v239, s[44:47], s64 offen sc1
  v_mov_b32 v44, v26
  s_nop 1
  v_max_f32_dpp v44, v44, v44 quad_perm:[1,0,3,2] row_mask:0xf bank_mask:0xf
  s_nop 1
  v_max_f32_dpp v44, v44, v44 quad_perm:[2,3,0,1] row_mask:0xf bank_mask:0xf
  s_nop 1
  v_max_f32_dpp v44, v44, v44 row_half_mirror row_mask:0xf bank_mask:0xf
  v_mov_b32_dpp v45, v26 row_ror:8 row_mask:0xf bank_mask:0xf
  v_sub_f32 v46, v26, v44
  v_mul_f32 v46, s91, v46
  v_exp_f32 v46, v46
  s_nop 0
  v_mul_f32 v47, v46, v45
  s_nop 1
  v_add_f32_dpp v47, v47, v47 quad_perm:[1,0,3,2] row_mask:0xf bank_mask:0xf
  s_nop 1
  v_add_f32_dpp v47, v47, v47 quad_perm:[2,3,0,1] row_mask:0xf bank_mask:0xf
  s_nop 1
  v_add_f32_dpp v47, v47, v47 row_half_mirror row_mask:0xf bank_mask:0xf
  v_rcp_f32 v47, v47
  s_nop 0
  v_mul_f32 v46, v46, v47
  s_nop 0
  v_readlane_b32 s82, v46, 0
  v_readlane_b32 s83, v46, 1
  v_readlane_b32 s84, v46, 2
  v_readlane_b32 s85, v46, 3
  v_readlane_b32 s86, v46, 4
  v_readlane_b32 s87, v46, 5
  v_readlane_b32 s88, v46, 6
  v_readlane_b32 s89, v46, 7
  s_waitcnt vmcnt(0)
  v_xor_b32 v48, s35, v29
  v_xor_b32 v49, s35, v31
  v_or_b32 v48, v48, v49
  v_xor_b32 v49, s35, v33
  v_or_b32 v48, v48, v49
  v_xor_b32 v49, s35, v35
  v_or_b32 v48, v48, v49
  v_xor_b32 v49, s35, v37
  v_or_b32 v48, v48, v49
  v_xor_b32 v49, s35, v39
  v_or_b32 v48, v48, v49
  v_xor_b32 v49, s35, v41
  v_or_b32 v48, v48, v49
  v_xor_b32 v49, s35, v43
  v_or_b32 v48, v48, v49
  v_cmp_ne_u32 vcc, 0, v48
  s_cbranch_vccz L_o_ok
  s_sub_u32 s90, s90, 1
  s_cmp_eq_u32 s90, 0
  s_cbranch_scc1 L_o_ok
  s_branch L_gather_o
L_o_ok:
  v_mul_f32 v48, s82, v28
  v_fmac_f32 v48, s83, v30
  v_fmac_f32 v48, s84, v32
  v_fmac_f32 v48, s85, v34
  v_fmac_f32 v48, s86, v36
  v_fmac_f32 v48, s87, v38
  v_fmac_f32 v48, s88, v40
  v_fmac_f32 v48, s89, v42
  v_cvt_pk_bf16_f32 v48, v48, v48
  ds_write_b16 v241, v48
  s_waitcnt lgkmcnt(0)
  s_barrier
  ds_read_b128 v[32:35], v242
  ds_read_b128 v[36:39], v242 offset:16
  s_lshl_b32 s64, s30, 3
  s_or_b32 s64, s64, s32
  s_lshl_b32 s64, s64, 4
  s_mul_i32 s65, s64, 1152
  s_add_u32 s65, s65, 655360
  s_mul_i32 s64, s31, 1152
  s_add_u32 s64, s64, s65
  s_waitcnt lgkmcnt(0)
  v_perm_b32 v110, v32, v32, v94
  v_perm_b32 v111, v32, v32, v95
  v_perm_b32 v112, v32, v32, v96
  v_perm_b32 v113, v32, v32, v97
  v_perm_b32 v114, v32, v32, v98
  v_perm_b32 v115, v32, v32, v99
  v_perm_b32 v116, v32, v32, v100
  v_perm_b32 v117, v32, v32, v101
  v_perm_b32 v118, v33, v33, v94
  v_perm_b32 v119, v33, v33, v95
  v_perm_b32 v120, v33, v33, v96
  v_perm_b32 v121, v33, v33, v97
  v_mfma_f32_16x16x32_bf16 v[20:23], v[164:167], v[110:113], 0
  v_perm_b32 v122, v33, v33, v98
  v_perm_b32 v123, v33, v33, v99
  v_perm_b32 v124, v33, v33, v100
  v_perm_b32 v125, v33, v33, v101
  v_mfma_f32_16x16x32_bf16 v[24:27], v[168:171], v[114:117], 0
  v_perm_b32 v110, v34, v34, v94
  v_perm_b32 v111, v34, v34, v95
  v_perm_b32 v112, v34, v34, v96
  v_perm_b32 v113, v34, v34, v97
  v_mfma_f32_16x16x32_bf16 v[20:23], v[172:175], v[118:121], v[20:23]
  v_perm_b32 v114, v34, v34, v98
  v_perm_b32 v115, v34, v34, v99
  v_perm_b32 v116, v34, v34, v100
  v_perm_b32 v117, v34, v34, v101
  v_mfma_f32_16x16x32_bf16 v[24:27], v[176:179], v[122:125], v[24:27]
  v_perm_b32 v118, v35, v35, v94
  v_perm_b32 v119, v35, v35, v95
  v_perm_b32 v120, v35, v35, v96
  v_perm_b32 v121, v35, v35, v97
  v_mfma_f32_16x16x32_bf16 v[20:23], v[180:183], v[110:113], v[20:23]
  v_perm_b32 v122, v35, v35, v98
  v_perm_b32 v123, v35, v35, v99
  v_perm_b32 v124, v35, v35, v100
  v_perm_b32 v125, v35, v35, v101
  v_mfma_f32_16x16x32_bf16 v[24:27], v[184:187], v[114:117], v[24:27]
  v_perm_b32 v110, v36, v36, v94
  v_perm_b32 v111, v36, v36, v95
  v_perm_b32 v112, v36, v36, v96
  v_perm_b32 v113, v36, v36, v97
  v_mfma_f32_16x16x32_bf16 v[20:23], v[188:191], v[118:121], v[20:23]
  v_perm_b32 v114, v36, v36, v98
  v_perm_b32 v115, v36, v36, v99
  v_perm_b32 v116, v36, v36, v100
  v_perm_b32 v117, v36, v36, v101
  v_mfma_f32_16x16x32_bf16 v[24:27], v[192:195], v[122:125], v[24:27]
  v_perm_b32 v118, v37, v37, v94
  v_perm_b32 v119, v37, v37, v95
  v_perm_b32 v120, v37, v37, v96
  v_perm_b32 v121, v37, v37, v97
  v_mfma_f32_16x16x32_bf16 v[20:23], v[196:199], v[110:113], v[20:23]
  v_perm_b32 v122, v37, v37, v98
  v_perm_b32 v123, v37, v37, v99
  v_perm_b32 v124, v37, v37, v100
  v_perm_b32 v125, v37, v37, v101
  v_mfma_f32_16x16x32_bf16 v[24:27], v[200:203], v[114:117], v[24:27]
  v_perm_b32 v110, v38, v38, v94
  v_perm_b32 v111, v38, v38, v95
  v_perm_b32 v112, v38, v38, v96
  v_perm_b32 v113, v38, v38, v97
  v_mfma_f32_16x16x32_bf16 v[20:23], v[204:207], v[118:121], v[20:23]
  v_perm_b32 v114, v38, v38, v98
  v_perm_b32 v115, v38, v38, v99
  v_perm_b32 v116, v38, v38, v100
  v_perm_b32 v117, v38, v38, v101
  v_mfma_f32_16x16x32_bf16 v[24:27], v[208:211], v[122:125], v[24:27]
  v_perm_b32 v118, v39, v39, v94
  v_perm_b32 v119, v39, v39, v95
  v_perm_b32 v120, v39, v39, v96
  v_perm_b32 v121, v39, v39, v97
  v_mfma_f32_16x16x32_bf16 v[20:23], v[212:215], v[110:113], v[20:23]
  v_perm_b32 v122, v39, v39, v98
  v_perm_b32 v123, v39, v39, v99
  v_perm_b32 v124, v39, v39, v100
  v_perm_b32 v125, v39, v39, v101
  v_mfma_f32_16x16x32_bf16 v[24:27], v[216:219], v[114:117], v[24:27]
  v_mfma_f32_16x16x32_bf16 v[20:23], v[220:223], v[118:121], v[20:23]
  v_mfma_f32_16x16x32_bf16 v[24:27], v[224:227], v[122:125], v[24:27]
  s_nop 7
  v_add_f32 v20, v20, v24
  v_add_f32 v21, v21, v25
  v_add_f32 v22, v22, v26
  v_add_f32 v23, v23, v27
  v_cndmask_b32 v28, v20, v22, s[74:75]
  v_cndmask_b32 v29, v21, v23, s[74:75]
  ds_write_b32 v243, v28
  ds_write_b32 v243, v29 offset:32
  s_waitcnt lgkmcnt(0)
  s_barrier
  s_cmp_lt_u32 s34, 3
  s_cbranch_scc0 L_end
  s_cmp_lt_u32 s34, 2
  s_cbranch_scc0 L_ypub_done
  ds_read_b32 v28, v244 offset:0
  ds_read_b32 v29, v244 offset:512
  ds_read_b32 v30, v244 offset:1024
  ds_read_b32 v31, v244 offset:1536
  v_cmp_gt_u32 vcc, 72, v0
  s_waitcnt lgkmcnt(0)
  v_add_f32 v28, v28, v29
  v_add_f32 v30, v30, v31
  v_add_f32 v28, v28, v30
  v_mov_b32 v29, s35
  s_and_saveexec_b64 s[94:95], vcc
  buffer_store_dwordx2 v[28:29], v245, s[44:47], s64 offen sc1
  s_mov_b64 exec, s[94:95]
L_ypub_done:
  s_cmp_eq_u32 s31, s32
  s_cbranch_scc0 L_end
  s_branch L_final
L_bpub:
  s_cmp_lt_u32 s34, 6
  s_cbranch_scc0 L_end
  v_subrev_u32 v24, 256, v0
  v_min_u32 v25, 71, v24
  v_lshlrev_b32 v26, 2, v25
  v_add_u32 v26, 153344, v26
  ds_read_b32 v28, v26 offset:0
  ds_read_b32 v29, v26 offset:512
  ds_read_b32 v30, v26 offset:1024
  ds_read_b32 v31, v26 offset:1536
  s_lshl_b32 s64, s30, 3
  s_or_b32 s64, s64, s32
  s_lshl_b32 s64, s64, 4
  s_add_u32 s64, s64, s31
  s_mul_i32 s64, s64, 1152
  s_add_u32 s64, s64, 655368
  v_lshlrev_b32 v25, 4, v25
  v_cmp_gt_u32 vcc, 72, v24
  s_waitcnt lgkmcnt(0)
  v_add_f32 v28, v28, v29
  v_add_f32 v30, v30, v31
  v_add_f32 v28, v28, v30
  v_mov_b32 v29, s35
  s_and_saveexec_b64 s[94:95], vcc
  buffer_store_dwordx2 v[28:29], v25, s[44:47], s64 offen sc1
  s_mov_b64 exec, s[94:95]
  s_branch L_end
L_final:
L_gather_y:
  s_mov_b32 s64, s65
  buffer_load_dwordx2 v[48:49], v246, s[44:47], s64 offen sc1
  s_add_u32 s64, s64, 1152
  buffer_load_dwordx2 v[50:51], v246, s[44:47], s64 offen sc1
  s_add_u32 s64, s64, 1152
  buffer_load_dwordx2 v[52:53], v246, s[44:47], s64 offen sc1
  s_add_u32 s64, s64, 1152
  buffer_load_dwordx2 v[54:55], v246, s[44:47], s64 offen sc1
  s_add_u32 s64, s64, 1152
  buffer_load_dwordx2 v[56:57], v246, s[44:47], s64 offen sc1
  s_add_u32 s64, s64, 1152
  buffer_load_dwordx2 v[58:59], v246, s[44:47], s64 offen sc1
  s_add_u32 s64, s64, 1152
  buffer_load_dwordx2 v[60:61], v246, s[44:47], s64 offen sc1
  s_add_u32 s64, s64, 1152
  buffer_load_dwordx2 v[62:63], v246, s[44:47], s64 offen sc1
  s_add_u32 s64, s64, 1152
  buffer_load_dwordx2 v[64:65], v246, s[44:47], s64 offen sc1
  s_add_u32 s64, s64, 1152
  buffer_load_dwordx2 v[66:67], v246, s[44:47], s64 offen sc1
  s_add_u32 s64, s64, 1152
  buffer_load_dwordx2 v[68:69], v246, s[44:47], s64 offen sc1
  s_add_u32 s64, s64, 1152
  buffer_load_dwordx2 v[70:71], v246, s[44:47], s64 offen sc1
  s_add_u32 s64, s64, 1152
  buffer_load_dwordx2 v[72:73], v246, s[44:47], s64 offen sc1
  s_add_u32 s64, s64, 1152
  buffer_load_dwordx2 v[74:75], v246, s[44:47], s64 offen sc1
  s_add_u32 s64, s64, 1152
  buffer_load_dwordx2 v[76:77], v246, s[44:47], s64 offen sc1
  s_add_u32 s64, s64, 1152
  buffer_load_dwordx2 v[78:79], v246, s[44:47], s64 offen sc1
  s_waitcnt vmcnt(0)
  v_xor_b32 v32, s35, v49
  v_xor_b32 v33, s35, v51
  v_or_b32 v32, v32, v33
  v_xor_b32 v33, s35, v53
  v_or_b32 v32, v32, v33
  v_xor_b32 v33, s35, v55
  v_or_b32 v32, v32, v33
  v_xor_b32 v33, s35, v57
  v_or_b32 v32, v32, v33
  v_xor_b32 v33, s35, v59
  v_or_b32 v32, v32, v33
  v_xor_b32 v33, s35, v61
  v_or_b32 v32, v32, v33
  v_xor_b32 v33, s35, v63
  v_or_b32 v32, v32, v33
  v_xor_b32 v33, s35, v65
  v_or_b32 v32, v32, v33
  v_xor_b32 v33, s35, v67
  v_or_b32 v32, v32, v33
  v_xor_b32 v33, s35, v69
  v_or_b32 v32, v32, v33
  v_xor_b32 v33, s35, v71
  v_or_b32 v32, v32, v33
  v_xor_b32 v33, s35, v73
  v_or_b32 v32, v32, v33
  v_xor_b32 v33, s35, v75
  v_or_b32 v32, v32, v33
  v_xor_b32 v33, s35, v77
  v_or_b32 v32, v32, v33
  v_xor_b32 v33, s35, v79
  v_or_b32 v32, v32, v33
  v_cmp_ne_u32 vcc, 0, v32
  s_cbranch_vccz L_y_ok
  s_sub_u32 s90, s90, 1
  s_cmp_eq_u32 s90, 0
  s_cbranch_scc1 L_y_ok
  s_branch L_gather_y
L_y_ok:
  v_add_f32 v48, v48, v50
  v_add_f32 v52, v52, v54
  v_add_f32 v56, v56, v58
  v_add_f32 v60, v60, v62
  v_add_f32 v64, v64, v66
  v_add_f32 v68, v68, v70
  v_add_f32 v72, v72, v74
  v_add_f32 v76, v76, v78
  v_add_f32 v48, v48, v52
  v_add_f32 v56, v56, v60
  v_add_f32 v64, v64, v68
  v_add_f32 v72, v72, v76
  v_add_f32 v48, v48, v56
  v_add_f32 v64, v64, v72
  v_add_f32 v48, v48, v64
  v_cvt_pk_bf16_f32 v32, 0, v48
  s_nop 1
  v_mov_b32_dpp v33, v32 quad_perm:[1,0,3,2] row_mask:0xf bank_mask:0xf
  v_lshlrev_b32 v41, 16, v247
  v_lshlrev_b32 v42, 16, v248
  s_mul_i32 s62, s30, 1152
  s_mul_i32 s63, s32, 144
  s_add_u32 s62, s62, s63
  v_add_f32 v32, v41, v32
  v_cvt_pk_bf16_f32 v32, 0, v32
  v_add_f32 v33, v33, v42
  v_cvt_pk_bf16_f32 v33, 0, v33
  v_add_f32 v32, v32, v33
  v_cvt_pk_bf16_f32 v32, v32, v32
  v_and_b32 v33, 1, v0
  v_cmp_eq_u32 vcc, 0, v33
  s_nop 0
  s_mov_b64 s[96:97], vcc
  v_cmp_gt_u32 vcc, 144, v0
  s_nop 0
  s_and_b64 vcc, vcc, s[96:97]
  s_and_saveexec_b64 s[94:95], vcc
  buffer_store_short v32, v249, s[48:51], s62 offen
  s_mov_b64 exec, s[94:95]
  s_or_b32 s63, s32, s34
  s_cmp_eq_u32 s63, 0
  s_cbranch_scc0 L_end
  s_lshl_b32 s63, s30, 8
  v_mov_b32 v33, s35
  v_mov_b32 v34, 0
  s_mov_b64 exec, 1
  buffer_store_dword v33, v34, s[44:47], s63 offen sc1
L_end:
L_exit:
  s_endpgm
.section .rodata,"a"
.p2align 6
.amdhsa_kernel parallel_sum__gqa_block_cached__dense_activation_squared_relu__decode_kernel
  .amdhsa_next_free_vgpr 256
  .amdhsa_next_free_sgpr 102
  .amdhsa_accum_offset 256
  .amdhsa_group_segment_fixed_size 0
  .amdhsa_kernarg_size 104
  .amdhsa_user_sgpr_count 2
  .amdhsa_user_sgpr_kernarg_segment_ptr 1
  .amdhsa_system_sgpr_workgroup_id_x 1
  .amdhsa_float_denorm_mode_32 3
.end_amdhsa_kernel
```
